```python
import torch

def _softmax(x, axis=-1):
    return torch.softmax(x, dim=axis)
def _gelu(x):
    return torch.nn.functional.gelu(x, approximate="tanh")
def _silu(x):
    return torch.nn.functional.silu(x)
def _sigmoid(x):
    return torch.sigmoid(x)
def _layernorm(x, axis=-1, eps=1e-5):
    m = x.mean(dim=axis, keepdim=True)
    v = x.var(dim=axis, keepdim=True, unbiased=False)
    return (x - m) / torch.sqrt(v + eps)
def _scatter_add(tgt, idx, src, axis=0):
    return tgt.clone().index_add_(axis, idx, src)
def _segment_sum(src, seg, n):
    out = torch.zeros((n,) + src.shape[1:], dtype=src.dtype)
    return out.index_add_(0, seg, src)
def _pad(x, pw):
    flat = tuple(v for pair in reversed(pw) for v in pair)
    return torch.nn.functional.pad(x, flat)

kernel_name = 'standalone__gqa_block_cached__sampling'

def setup_inputs():

    _w = (lambda a: (lambda t: t.to(torch.bfloat16) if t.is_floating_point() else t)(torch.as_tensor(a)))
    B, Sq, D = 8, 4, 1024
    Hq, Hkv, Sk, Dh = 32, 4, 8192, 128
    assert Hq % Hkv == 0, (Hq, Hkv)
    return {
        "x": _w((lambda *s: torch.randn(*s, dtype=torch.bfloat16) * 0.8)(B, Sq, D)),
        "k_cache": _w((lambda *s: torch.randn(*s, dtype=torch.bfloat16) * 0.8)(B, Hkv, Sk, Dh)),
        "v_cache": _w((lambda *s: torch.randn(*s, dtype=torch.bfloat16) * 0.05)(B, Hkv, Sk, Dh)),
        "wq": _w((lambda *s: torch.randn(*s, dtype=torch.bfloat16) * 0.8)(D, Hq * Dh) * (D ** -0.5)),
        "wo": _w((lambda *s: torch.randn(*s, dtype=torch.bfloat16) * 0.05)(Hq * Dh, D) * ((Hq * Dh) ** -0.5)),
    }

def reference(x, k_cache, v_cache, wq, wo):
    B, Sq, D = x.shape
    Hq, Dh = 32, 128
    Hkv = k_cache.shape[1]
    rep = Hq // Hkv
    q = (lambda x, *d: x.permute(*d))((x @ wq).reshape(B, Sq, Hq, Dh), 0, 2, 1, 3)
    k = (lambda x, n, axis: torch.repeat_interleave(x, n, dim=axis))(k_cache, rep, axis=1)
    v = (lambda x, n, axis: torch.repeat_interleave(x, n, dim=axis))(v_cache, rep, axis=1)
    scores = torch.einsum("bhqd,bhkd->bhqk", q, k) * (Dh ** -0.5)
    p = _softmax(scores, axis=-1)
    o = torch.einsum("bhqk,bhkd->bhqd", p, v)
    return (lambda x, *d: x.permute(*d))(o, 0, 2, 1, 3).reshape(B, Sq, Hq * Dh) @ wo
```

```asm
; @launch grid=(256,1,1) block=(512,1,1) lds=155648
.amdgcn_target "amdgcn-amd-amdhsa--gfx950"
.text
.globl standalone__gqa_block_cached__sampling_kernel
.p2align 8
.type standalone__gqa_block_cached__sampling_kernel,@function
standalone__gqa_block_cached__sampling_kernel:
    s_cmp_ge_u32 s2, 256
    s_cbranch_scc1 L_exit
    s_load_dwordx16 s[64:79], s[0:1], 0
    s_memrealtime s[100:101]
    v_lshrrev_b32 v1, 6, v0
    v_and_b32 v0, 63, v0
    v_readfirstlane_b32 s3, v1
    s_and_b32 s4, s2, 7
    s_lshr_b32 s5, s2, 3
    s_lshl_b32 s41, s4, 5
    s_add_u32 s41, s41, s5
    s_and_b32 s80, s41, 0xc0
    s_lshl_b32 s7, s5, 1
    s_or_b32 s80, s80, s7
    s_and_b32 s7, s2, 1
    s_or_b32 s80, s80, s7
    s_and_b32 s45, s5, 15
    v_and_b32 v6, 15, v0
    v_lshrrev_b32 v7, 4, v0
    v_and_b32 v9, 1, v7
    v_lshlrev_b32 v9, 1, v9
    v_and_b32 v8, 7, v0
    v_xor_b32 v9, v9, v8
    v_lshlrev_b32 v9, 4, v9
    v_lshrrev_b32 v8, 3, v0
    v_lshl_add_u32 v10, v8, 13, v9
    v_xor_b32 v11, 64, v10
    v_xor_b32 v8, v6, v7
    v_lshlrev_b32 v8, 4, v8
    s_and_b32 s4, s3, 3
    s_lshl_b32 s5, s4, 6
    s_lshl_b32 s4, s4, 13
    v_xor_b32 v36, s5, v8
    v_lshl_add_u32 v36, v7, 11, v36
    v_add_u32 v36, s4, v36
    s_lshl_b32 s52, s3, 17
    s_lshr_b32 s53, s80, 2
    s_lshl_b32 s53, s53, 7
    s_add_u32 s52, s52, s53
    s_lshl_b32 s53, s3, 11
    s_lshr_b32 s54, s3, 2
    s_lshl_b32 s54, s54, 15
    s_lshl_b32 s55, s3, 10
    s_add_u32 s55, s55, 131072
    s_and_b32 s86, s80, 3
    s_add_u32 s87, s86, 4
    v_mov_b32 v251, 0
    s_waitcnt lgkmcnt(0)
    s_mov_b32 s32, s76
    s_and_b32 s33, s77, 0xffff
    s_mov_b32 s34, 0x100
    s_mov_b32 s35, 0x20000
    s_or_b32 s4, s2, s3
    s_cbranch_scc1 L_nonon_1
    s_or_b32 s100, s100, 1
    v_mov_b32 v248, s100
    v_mov_b32 v249, s101
    s_mov_b64 exec, 1
    buffer_store_dwordx2 v[248:249], v251, s[32:35], 0 offen sc1
    s_mov_b64 exec, -1
L_nonon_1:
    s_mov_b32 s20, s70
    s_and_b32 s21, s71, 0xffff
    s_mov_b32 s22, 0x800000
    s_mov_b32 s23, 0x20000
    s_mov_b32 s8, s64
    s_and_b32 s9, s65, 0xffff
    s_mov_b32 s10, 0x10000
    s_mov_b32 s11, 0x20000
    s_add_u32 m0, s53, 0
    s_lshl_b32 s56, s86, 20
    s_add_u32 s56, s56, s52
    s_add_u32 s56, s56, 0
    buffer_load_dwordx4 v10, s[20:23], s56 offen nt lds
    s_add_u32 m0, s53, 1024
    s_lshl_b32 s56, s86, 20
    s_add_u32 s56, s56, s52
    s_add_u32 s56, s56, 65536
    buffer_load_dwordx4 v11, s[20:23], s56 offen nt lds
    s_mov_b32 s12, s66
    s_and_b32 s13, s67, 0xffff
    s_mov_b32 s14, 0x4000000
    s_mov_b32 s15, 0x20000
    s_mov_b32 s6, s41
    s_lshr_b32 s42, s6, 5
    s_lshr_b32 s43, s6, 3
    s_and_b32 s43, s43, 3
    s_and_b32 s44, s6, 7
    s_lshr_b32 s46, s41, 4
    s_xor_b32 s46, s46, 2
    s_lshl_b32 s49, s3, 10
    s_lshl_b32 s48, s6, 18
    s_add_u32 s48, s48, s49
    s_add_u32 s49, s49, 65536
    s_and_b32 s4, s3, 3
    s_lshl_b32 s4, s4, 6
    v_xor_b32 v16, s4, v8
    v_lshl_add_u32 v16, v7, 8, v16
    s_barrier
    buffer_load_dwordx2 v[246:247], v251, s[32:35], 0 offen sc1
    s_add_u32 m0, s49, 0
    s_xor_b32 s57, s48, 0
    buffer_load_dwordx4 v16, s[12:15], s57 offen nt lds
    s_add_u32 m0, s55, 0
    s_lshl_b32 s56, s86, 8
    s_add_u32 s56, s56, s54
    buffer_load_dwordx4 v36, s[8:11], s56 offen lds
    s_add_u32 m0, s53, 16384
    s_lshl_b32 s56, s87, 20
    s_add_u32 s56, s56, s52
    s_add_u32 s56, s56, 0
    buffer_load_dwordx4 v10, s[20:23], s56 offen nt lds
    s_barrier
    s_add_u32 m0, s49, 8192
    s_xor_b32 s57, s48, 8192
    buffer_load_dwordx4 v16, s[12:15], s57 offen nt lds
    s_add_u32 m0, s53, 17408
    s_lshl_b32 s56, s87, 20
    s_add_u32 s56, s56, s52
    s_add_u32 s56, s56, 65536
    buffer_load_dwordx4 v11, s[20:23], s56 offen nt lds
    s_add_u32 m0, s55, 8192
    s_lshl_b32 s56, s87, 8
    s_add_u32 s56, s56, s54
    buffer_load_dwordx4 v36, s[8:11], s56 offen lds
    s_barrier
    s_add_u32 m0, s49, 16384
    s_xor_b32 s57, s48, 16384
    buffer_load_dwordx4 v16, s[12:15], s57 offen nt lds
    s_add_u32 m0, s49, 24576
    s_xor_b32 s57, s48, 24576
    buffer_load_dwordx4 v16, s[12:15], s57 offen nt lds
    s_mov_b32 s36, s78
    s_and_b32 s37, s79, 0xffff
    s_mov_b32 s38, 0x800000
    s_mov_b32 s39, 0x20000
    v_lshlrev_b32 v3, 4, v0
    v_lshrrev_b32 v13, 2, v6
    v_and_b32 v14, 3, v6
    v_lshrrev_b32 v24, 3, v0
    v_lshlrev_b32 v25, 4, v24
    v_lshlrev_b32 v24, 17, v24
    v_and_b32 v26, 7, v0
    v_lshl_add_u32 v24, v26, 4, v24
    v_lshl_add_u32 v25, v14, 2, v25
    v_bfe_u32 v26, v0, 2, 1
    v_lshl_add_u32 v25, v26, 7, v25
    s_lshr_b32 s98, s3, 2
    s_lshl_b32 s98, s98, 19
    s_lshr_b32 s5, s41, 6
    s_lshl_b32 s5, s5, 15
    s_add_u32 s98, s98, s5
    s_and_b32 s5, s80, 3
    s_lshl_b32 s5, s5, 13
    s_add_u32 s98, s98, s5
    s_and_b32 s5, s80, 60
    s_lshl_b32 s5, s5, 7
    s_add_u32 s98, s98, s5
    s_and_b32 s5, s3, 3
    s_lshl_b32 s5, s5, 7
    s_add_u32 s98, s98, s5
    s_and_b32 s47, s6, 31
    s_lshl_b32 s47, s47, 3
    s_add_u32 s47, s47, s42
    s_lshl_b32 s47, s47, 10
    s_lshl_b32 s4, s3, 7
    s_add_u32 s47, s47, s4
    s_add_u32 s47, s47, 0x140000
    s_lshl_b32 s62, s6, 9
    s_add_u32 s62, s62, 0x100000
    v_mov_b32 v252, -1
    v_mov_b32 v253, -1
    v_mov_b32 v254, -1
    v_mov_b32 v255, -1
    s_lshr_b32 s4, s3, 2
    s_lshl_b32 s4, s4, 12
    s_add_u32 s4, s4, 131072
    s_lshl_b32 s5, s3, 13
    s_add_u32 s5, s5, 65536
    v_xor_b32 v20, 0, v8
    v_lshl_add_u32 v20, v6, 8, v20
    v_add_u32 v44, s4, v20
    v_add_u32 v20, s5, v20
    v_xor_b32 v21, 64, v8
    v_lshl_add_u32 v21, v6, 8, v21
    v_add_u32 v45, s4, v21
    v_add_u32 v21, s5, v21
    v_xor_b32 v22, 128, v8
    v_lshl_add_u32 v22, v6, 8, v22
    v_add_u32 v46, s4, v22
    v_add_u32 v22, s5, v22
    v_xor_b32 v23, 192, v8
    v_lshl_add_u32 v23, v6, 8, v23
    v_add_u32 v47, s4, v23
    v_add_u32 v23, s5, v23
    v_and_b32 v9, 1, v7
    v_lshlrev_b32 v9, 1, v9
    v_lshrrev_b32 v10, 1, v13
    v_or_b32 v9, v9, v10
    s_and_b32 s4, s3, 3
    v_xor_b32 v9, s4, v9
    v_lshlrev_b32 v9, 5, v9
    v_lshl_add_u32 v9, v14, 3, v9
    v_lshl_add_u32 v11, v7, 3, v13
    v_lshl_add_u32 v11, v11, 7, v9
    s_mov_b32 s16, s68
    s_and_b32 s17, s69, 0xffff
    s_mov_b32 s18, 0x4000000
    s_mov_b32 s19, 0x20000
    s_mov_b32 s24, s72
    s_and_b32 s25, s73, 0xffff
    s_mov_b32 s26, 0x800000
    s_mov_b32 s27, 0x20000
    s_mov_b32 s28, s74
    s_and_b32 s29, s75, 0xffff
    s_mov_b32 s30, 0x10000
    s_mov_b32 s31, 0x20000
    s_lshl_b32 s59, s41, 3
    s_add_u32 s59, s59, s3
    s_lshl_b32 s59, s59, 10
    s_add_u32 s59, s59, 0x400000
    v_and_b32 v28, 1, v7
    v_lshl_add_u32 v28, v28, 2, v13
    v_xor_b32 v28, s3, v28
    v_lshlrev_b32 v28, 5, v28
    v_lshl_add_u32 v28, v14, 3, v28
    v_lshl_add_u32 v4, v7, 2, v13
    v_lshl_add_u32 v4, v4, 8, v28
    v_add_u32 v4, 65536, v4
    s_and_b32 s4, s3, 1
    s_lshl_b32 s4, s4, 1
    v_and_b32 v30, 1, v7
    v_or_b32 v30, s4, v30
    v_lshlrev_b32 v30, 1, v30
    v_and_b32 v28, 7, v0
    v_xor_b32 v30, v30, v28
    v_lshlrev_b32 v30, 4, v30
    v_lshrrev_b32 v28, 3, v0
    v_lshl_add_u32 v30, v28, 11, v30
    s_lshl_b32 s63, s45, 19
    s_lshl_b32 s4, s3, 14
    s_add_u32 s63, s63, s4
    s_lshl_b32 s4, s46, 7
    s_add_u32 s63, s63, s4
    s_lshl_b32 s4, s3, 11
    v_add_u32 v31, s4, v3
    s_mov_b32 s50, 0x3e0293ee
    v_lshlrev_b32 v10, 7, v0
    s_lshl_b32 s52, s43, 13
    s_add_u32 s52, s52, 0x120000
    s_cmp_lg_u32 s3, 1
    s_cbranch_scc1 L_w_2
    s_lshl_b32 s4, s42, 12
    v_add_u32 v28, s4, v10
    v_cmp_gt_u32 vcc, 32, v0
    v_bfe_u32 v10, v0, 1, 3
    v_lshlrev_b32 v10, 12, v10
    v_and_b32 v27, 1, v0
    v_lshl_add_u32 v10, v27, 7, v10
    s_lshl_b32 s4, s45, 8
    v_add_u32 v10, s4, v10
    s_mov_b32 s52, 0x120000
    v_cndmask_b32 v10, v10, v28, vcc
L_w_2:
    s_lshl_b32 s54, s42, 2
    s_add_u32 s54, s54, s43
    s_lshl_b32 s54, s54, 15
    s_and_b32 s4, s3, 1
    s_lshl_b32 s4, s4, 12
    s_add_u32 s54, s54, s4
    s_lshr_b32 s4, s3, 1
    s_lshl_b32 s4, s4, 8
    s_add_u32 s54, s54, s4
    v_lshlrev_b32 v12, 10, v13
    v_lshl_add_u32 v12, v7, 6, v12
    v_lshl_add_u32 v12, v14, 4, v12
    s_lshl_b32 s4, s3, 10
    s_add_u32 s4, s4, 133120
    v_add_u32 v5, s4, v3
    v_add_u32 v1, 133120, v3
    v_and_b32 v17, 31, v0
    v_lshlrev_b32 v17, 5, v17
    s_lshl_b32 s4, s3, 2
    s_add_u32 s4, s4, 131072
    v_add_u32 v18, s4, v17
    v_lshlrev_b32 v19, 5, v6
    v_add_u32 v19, 131072, v19
    s_waitcnt vmcnt(2)
    s_barrier
    s_add_u32 m0, s49, 32768
    s_xor_b32 s57, s48, 32768
    buffer_load_dwordx4 v16, s[12:15], s57 offen nt lds
    ds_read_b64_tr_b16 v[64:65], v11 offset:0
    ds_read_b64_tr_b16 v[66:67], v11 offset:512
    ds_read_b128 v[80:83], v44 offset:0
    ds_read_b64_tr_b16 v[68:69], v11 offset:4096
    ds_read_b64_tr_b16 v[70:71], v11 offset:4608
    ds_read_b128 v[84:87], v45 offset:0
    ds_read_b64_tr_b16 v[72:73], v11 offset:8192
    ds_read_b64_tr_b16 v[74:75], v11 offset:8704
    ds_read_b128 v[88:91], v46 offset:0
    ds_read_b64_tr_b16 v[76:77], v11 offset:12288
    ds_read_b64_tr_b16 v[78:79], v11 offset:12800
    ds_read_b128 v[92:95], v47 offset:0
    s_waitcnt lgkmcnt(9)
    v_mfma_f32_16x16x32_bf16 v[32:35], v[64:67], v[80:83], 0
    s_waitcnt lgkmcnt(6)
    v_mfma_f32_16x16x32_bf16 v[32:35], v[68:71], v[84:87], v[32:35]
    s_waitcnt lgkmcnt(3)
    v_mfma_f32_16x16x32_bf16 v[32:35], v[72:75], v[88:91], v[32:35]
    s_waitcnt lgkmcnt(0)
    v_mfma_f32_16x16x32_bf16 v[32:35], v[76:79], v[92:95], v[32:35]
    s_add_u32 m0, s49, 40960
    s_xor_b32 s57, s48, 40960
    buffer_load_dwordx4 v16, s[12:15], s57 offen nt lds
    ds_read_b64_tr_b16 v[96:97], v11 offset:16384
    ds_read_b64_tr_b16 v[98:99], v11 offset:16896
    ds_read_b128 v[112:115], v44 offset:8192
    ds_read_b64_tr_b16 v[100:101], v11 offset:20480
    ds_read_b64_tr_b16 v[102:103], v11 offset:20992
    ds_read_b128 v[116:119], v45 offset:8192
    ds_read_b64_tr_b16 v[104:105], v11 offset:24576
    ds_read_b64_tr_b16 v[106:107], v11 offset:25088
    ds_read_b128 v[120:123], v46 offset:8192
    ds_read_b64_tr_b16 v[108:109], v11 offset:28672
    ds_read_b64_tr_b16 v[110:111], v11 offset:29184
    ds_read_b128 v[124:127], v47 offset:8192
    s_waitcnt lgkmcnt(9)
    v_mfma_f32_16x16x32_bf16 v[32:35], v[96:99], v[112:115], v[32:35]
    s_waitcnt lgkmcnt(6)
    v_mfma_f32_16x16x32_bf16 v[32:35], v[100:103], v[116:119], v[32:35]
    s_waitcnt lgkmcnt(3)
    v_mfma_f32_16x16x32_bf16 v[32:35], v[104:107], v[120:123], v[32:35]
    s_waitcnt lgkmcnt(0)
    v_mfma_f32_16x16x32_bf16 v[32:35], v[108:111], v[124:127], v[32:35]
    s_and_b32 s4, s3, 1
    s_lshl_b32 s4, s4, 2
    v_add_u32 v2, s4, v7
    v_lshlrev_b32 v2, 1, v2
    v_xor_b32 v2, v2, v6
    v_lshlrev_b32 v2, 4, v2
    v_lshl_add_u32 v2, v7, 8, v2
    s_nop 1
    v_cvt_pk_bf16_f32 v36, v32, v33
    v_cvt_pk_bf16_f32 v37, v34, v35
    v_mov_b32 v38, v36
    v_mov_b32 v39, v37
    s_nop 1
    v_permlane16_swap_b32 v36, v38
    v_permlane16_swap_b32 v37, v39
    ds_bpermute_b32 v40, v25, v36
    ds_bpermute_b32 v41, v25, v37
    ds_bpermute_b32 v42, v25, v38
    ds_bpermute_b32 v43, v25, v39
    s_waitcnt lgkmcnt(0)
    s_mov_b64 exec, 0xffffffff
    buffer_store_dwordx4 v[40:43], v24, s[36:39], s98 offen sc1
    s_mov_b64 exec, 0xff
    buffer_store_dwordx4 v[252:255], v3, s[36:39], s47 offen sc1
    s_mov_b64 exec, -1
    v_add_u32 v29, 65536, v11
    s_waitcnt vmcnt(11)
    s_barrier
    s_cmp_lg_u32 s3, 0
    s_cbranch_scc1 L_w_3
    ds_read_b128 v[128:131], v20 offset:0
    ds_read_b128 v[132:135], v21 offset:0
    ds_read_b128 v[136:139], v22 offset:0
    ds_read_b128 v[140:143], v23 offset:0
    ds_read_b128 v[144:147], v20 offset:4096
    ds_read_b128 v[148:151], v21 offset:4096
    ds_read_b128 v[152:155], v22 offset:4096
    ds_read_b128 v[156:159], v23 offset:4096
L_w_3:
    s_waitcnt vmcnt(12)
    s_mov_b32 s51, 200000
L_nonw_4:
    v_readfirstlane_b32 s100, v246
    v_readfirstlane_b32 s101, v247
    s_cmp_lg_u32 s100, 0
    s_cbranch_scc1 L_nonok_5
    s_sleep 4
    buffer_load_dwordx2 v[246:247], v251, s[32:35], 0 offen sc1
    s_sub_u32 s51, s51, 1
    s_waitcnt vmcnt(0)
    s_cbranch_scc0 L_nonw_4
    s_endpgm
L_nonok_5:
    s_waitcnt lgkmcnt(0)
    s_waitcnt vmcnt(8)
    s_barrier
    s_cmp_lg_u32 s3, 1
    s_cbranch_scc1 L_w_6
    ds_read_b128 v[128:131], v20 offset:0
    ds_read_b128 v[132:135], v21 offset:0
    ds_read_b128 v[136:139], v22 offset:0
    ds_read_b128 v[140:143], v23 offset:0
    ds_read_b128 v[144:147], v20 offset:4096
    ds_read_b128 v[148:151], v21 offset:4096
    ds_read_b128 v[152:155], v22 offset:4096
    ds_read_b128 v[156:159], v23 offset:4096
L_w_6:
    s_waitcnt lgkmcnt(0)
    s_waitcnt vmcnt(5)
    s_barrier
    s_add_u32 m0, s49, 49152
    s_xor_b32 s57, s48, 49152
    buffer_load_dwordx4 v16, s[12:15], s57 offen nt lds
    s_cmp_lg_u32 s3, 2
    s_cbranch_scc1 L_w_7
    ds_read_b128 v[128:131], v20 offset:0
    ds_read_b128 v[132:135], v21 offset:0
    ds_read_b128 v[136:139], v22 offset:0
    ds_read_b128 v[140:143], v23 offset:0
    ds_read_b128 v[144:147], v20 offset:4096
    ds_read_b128 v[148:151], v21 offset:4096
    ds_read_b128 v[152:155], v22 offset:4096
    ds_read_b128 v[156:159], v23 offset:4096
L_w_7:
    s_waitcnt lgkmcnt(0)
    s_waitcnt vmcnt(5)
    s_barrier
    s_add_u32 m0, s49, 57344
    s_xor_b32 s57, s48, 57344
    buffer_load_dwordx4 v16, s[12:15], s57 offen nt lds
    s_cmp_lg_u32 s3, 3
    s_cbranch_scc1 L_w_8
    ds_read_b128 v[128:131], v20 offset:0
    ds_read_b128 v[132:135], v21 offset:0
    ds_read_b128 v[136:139], v22 offset:0
    ds_read_b128 v[140:143], v23 offset:0
    ds_read_b128 v[144:147], v20 offset:4096
    ds_read_b128 v[148:151], v21 offset:4096
    ds_read_b128 v[152:155], v22 offset:4096
    ds_read_b128 v[156:159], v23 offset:4096
L_w_8:
    s_waitcnt lgkmcnt(0)
    s_waitcnt vmcnt(5)
    s_barrier
    s_add_u32 m0, s49, 0
    s_xor_b32 s57, s48, 65536
    buffer_load_dwordx4 v16, s[12:15], s57 offen nt lds
    s_cmp_lg_u32 s3, 4
    s_cbranch_scc1 L_w_9
    ds_read_b128 v[128:131], v20 offset:0
    ds_read_b128 v[132:135], v21 offset:0
    ds_read_b128 v[136:139], v22 offset:0
    ds_read_b128 v[140:143], v23 offset:0
    ds_read_b128 v[144:147], v20 offset:4096
    ds_read_b128 v[148:151], v21 offset:4096
    ds_read_b128 v[152:155], v22 offset:4096
    ds_read_b128 v[156:159], v23 offset:4096
L_w_9:
    s_waitcnt lgkmcnt(0)
    s_waitcnt vmcnt(5)
    s_barrier
    s_add_u32 m0, s49, 8192
    s_xor_b32 s57, s48, 73728
    buffer_load_dwordx4 v16, s[12:15], s57 offen nt lds
    s_cmp_lg_u32 s3, 5
    s_cbranch_scc1 L_w_10
    ds_read_b128 v[128:131], v20 offset:0
    ds_read_b128 v[132:135], v21 offset:0
    ds_read_b128 v[136:139], v22 offset:0
    ds_read_b128 v[140:143], v23 offset:0
    ds_read_b128 v[144:147], v20 offset:4096
    ds_read_b128 v[148:151], v21 offset:4096
    ds_read_b128 v[152:155], v22 offset:4096
    ds_read_b128 v[156:159], v23 offset:4096
L_w_10:
    s_waitcnt lgkmcnt(0)
    s_waitcnt vmcnt(3)
    s_waitcnt vmcnt(4)
    s_barrier
    s_cmp_lg_u32 s3, 0
    s_cbranch_scc1 L_w_11
    s_lshl_b32 s5, s41, 7
    s_add_u32 s5, s5, 0x120000
    s_getreg_b32 s4, hwreg(HW_REG_XCC_ID)
    v_mov_b32 v244, v246
    v_mov_b32 v245, v247
    v_mov_b32 v246, s4
    s_mov_b64 exec, 0xff
    buffer_store_dwordx4 v[244:247], v3, s[36:39], s5 offen sc1
    s_mov_b64 exec, -1
L_w_11:
    s_add_u32 m0, s49, 16384
    s_xor_b32 s57, s48, 81920
    buffer_load_dwordx4 v16, s[12:15], s57 offen nt lds
    s_cmp_lg_u32 s3, 6
    s_cbranch_scc1 L_w_12
    ds_read_b128 v[128:131], v20 offset:0
    ds_read_b128 v[132:135], v21 offset:0
    ds_read_b128 v[136:139], v22 offset:0
    ds_read_b128 v[140:143], v23 offset:0
    ds_read_b128 v[144:147], v20 offset:4096
    ds_read_b128 v[148:151], v21 offset:4096
    ds_read_b128 v[152:155], v22 offset:4096
    ds_read_b128 v[156:159], v23 offset:4096
L_w_12:
    s_waitcnt lgkmcnt(0)
    s_waitcnt vmcnt(3)
    s_barrier
    s_add_u32 m0, s49, 24576
    s_xor_b32 s57, s48, 90112
    buffer_load_dwordx4 v16, s[12:15], s57 offen nt lds
    s_cmp_lg_u32 s3, 7
    s_cbranch_scc1 L_w_13
    ds_read_b128 v[128:131], v20 offset:0
    ds_read_b128 v[132:135], v21 offset:0
    ds_read_b128 v[136:139], v22 offset:0
    ds_read_b128 v[140:143], v23 offset:0
    ds_read_b128 v[144:147], v20 offset:4096
    ds_read_b128 v[148:151], v21 offset:4096
    ds_read_b128 v[152:155], v22 offset:4096
    ds_read_b128 v[156:159], v23 offset:4096
L_w_13:
    s_waitcnt lgkmcnt(0)
    s_waitcnt vmcnt(3)
    s_barrier
    s_add_u32 m0, s49, 32768
    s_xor_b32 s57, s48, 98304
    buffer_load_dwordx4 v16, s[12:15], s57 offen nt lds
    s_cmp_lg_u32 s3, 0
    s_cbranch_scc1 L_w_14
    ds_read_b128 v[160:163], v20 offset:0
    ds_read_b128 v[164:167], v21 offset:0
    ds_read_b128 v[168:171], v22 offset:0
    ds_read_b128 v[172:175], v23 offset:0
    ds_read_b128 v[176:179], v20 offset:4096
    ds_read_b128 v[180:183], v21 offset:4096
    ds_read_b128 v[184:187], v22 offset:4096
    ds_read_b128 v[188:191], v23 offset:4096
L_w_14:
    s_waitcnt lgkmcnt(0)
    s_waitcnt vmcnt(3)
    s_barrier
    s_add_u32 m0, s49, 40960
    s_xor_b32 s57, s48, 106496
    buffer_load_dwordx4 v16, s[12:15], s57 offen nt lds
    s_cmp_lg_u32 s3, 1
    s_cbranch_scc1 L_w_15
    ds_read_b128 v[160:163], v20 offset:0
    ds_read_b128 v[164:167], v21 offset:0
    ds_read_b128 v[168:171], v22 offset:0
    ds_read_b128 v[172:175], v23 offset:0
    ds_read_b128 v[176:179], v20 offset:4096
    ds_read_b128 v[180:183], v21 offset:4096
    ds_read_b128 v[184:187], v22 offset:4096
    ds_read_b128 v[188:191], v23 offset:4096
L_w_15:
    s_waitcnt lgkmcnt(0)
    s_waitcnt vmcnt(3)
    s_barrier
    s_add_u32 m0, s49, 49152
    s_xor_b32 s57, s48, 114688
    buffer_load_dwordx4 v16, s[12:15], s57 offen nt lds
    s_cmp_lg_u32 s3, 2
    s_cbranch_scc1 L_w_16
    ds_read_b128 v[160:163], v20 offset:0
    ds_read_b128 v[164:167], v21 offset:0
    ds_read_b128 v[168:171], v22 offset:0
    ds_read_b128 v[172:175], v23 offset:0
    ds_read_b128 v[176:179], v20 offset:4096
    ds_read_b128 v[180:183], v21 offset:4096
    ds_read_b128 v[184:187], v22 offset:4096
    ds_read_b128 v[188:191], v23 offset:4096
L_w_16:
    s_waitcnt lgkmcnt(0)
    s_waitcnt vmcnt(3)
    s_barrier
    s_add_u32 m0, s49, 57344
    s_xor_b32 s57, s48, 122880
    buffer_load_dwordx4 v16, s[12:15], s57 offen nt lds
    s_cmp_lg_u32 s3, 3
    s_cbranch_scc1 L_w_17
    ds_read_b128 v[160:163], v20 offset:0
    ds_read_b128 v[164:167], v21 offset:0
    ds_read_b128 v[168:171], v22 offset:0
    ds_read_b128 v[172:175], v23 offset:0
    ds_read_b128 v[176:179], v20 offset:4096
    ds_read_b128 v[180:183], v21 offset:4096
    ds_read_b128 v[184:187], v22 offset:4096
    ds_read_b128 v[188:191], v23 offset:4096
L_w_17:
    s_waitcnt lgkmcnt(0)
    s_waitcnt vmcnt(3)
    s_barrier
    s_add_u32 m0, s49, 0
    s_xor_b32 s57, s48, 131072
    buffer_load_dwordx4 v16, s[12:15], s57 offen nt lds
    s_cmp_lg_u32 s3, 4
    s_cbranch_scc1 L_w_18
    ds_read_b128 v[160:163], v20 offset:0
    ds_read_b128 v[164:167], v21 offset:0
    ds_read_b128 v[168:171], v22 offset:0
    ds_read_b128 v[172:175], v23 offset:0
    ds_read_b128 v[176:179], v20 offset:4096
    ds_read_b128 v[180:183], v21 offset:4096
    ds_read_b128 v[184:187], v22 offset:4096
    ds_read_b128 v[188:191], v23 offset:4096
L_w_18:
    s_waitcnt lgkmcnt(0)
    s_waitcnt vmcnt(3)
    s_barrier
    s_add_u32 m0, s49, 8192
    s_xor_b32 s57, s48, 139264
    buffer_load_dwordx4 v16, s[12:15], s57 offen nt lds
    s_cmp_lg_u32 s3, 5
    s_cbranch_scc1 L_w_19
    ds_read_b128 v[160:163], v20 offset:0
    ds_read_b128 v[164:167], v21 offset:0
    ds_read_b128 v[168:171], v22 offset:0
    ds_read_b128 v[172:175], v23 offset:0
    ds_read_b128 v[176:179], v20 offset:4096
    ds_read_b128 v[180:183], v21 offset:4096
    ds_read_b128 v[184:187], v22 offset:4096
    ds_read_b128 v[188:191], v23 offset:4096
L_w_19:
    s_waitcnt lgkmcnt(0)
    s_waitcnt vmcnt(3)
    s_barrier
    s_cmp_gt_u32 s3, 1
    s_cbranch_scc1 L_w_20
    buffer_load_dwordx3 v[26:28], v10, s[36:39], s52 offen sc1
L_w_20:
    s_add_u32 m0, s49, 16384
    s_xor_b32 s57, s48, 147456
    buffer_load_dwordx4 v16, s[12:15], s57 offen nt lds
    s_cmp_lg_u32 s3, 6
    s_cbranch_scc1 L_w_21
    ds_read_b128 v[160:163], v20 offset:0
    ds_read_b128 v[164:167], v21 offset:0
    ds_read_b128 v[168:171], v22 offset:0
    ds_read_b128 v[172:175], v23 offset:0
    ds_read_b128 v[176:179], v20 offset:4096
    ds_read_b128 v[180:183], v21 offset:4096
    ds_read_b128 v[184:187], v22 offset:4096
    ds_read_b128 v[188:191], v23 offset:4096
L_w_21:
    s_waitcnt lgkmcnt(0)
    s_waitcnt vmcnt(3)
    s_barrier
    s_add_u32 m0, s49, 24576
    s_xor_b32 s57, s48, 155648
    buffer_load_dwordx4 v16, s[12:15], s57 offen nt lds
    s_cmp_lg_u32 s3, 7
    s_cbranch_scc1 L_w_22
    ds_read_b128 v[160:163], v20 offset:0
    ds_read_b128 v[164:167], v21 offset:0
    ds_read_b128 v[168:171], v22 offset:0
    ds_read_b128 v[172:175], v23 offset:0
    ds_read_b128 v[176:179], v20 offset:4096
    ds_read_b128 v[180:183], v21 offset:4096
    ds_read_b128 v[184:187], v22 offset:4096
    ds_read_b128 v[188:191], v23 offset:4096
L_w_22:
    s_waitcnt lgkmcnt(0)
    s_waitcnt vmcnt(3)
    s_barrier
    s_add_u32 m0, s49, 32768
    s_xor_b32 s57, s48, 163840
    buffer_load_dwordx4 v16, s[12:15], s57 offen nt lds
    s_cmp_lg_u32 s3, 0
    s_cbranch_scc1 L_w_23
    ds_read_b128 v[192:195], v20 offset:0
    ds_read_b128 v[196:199], v21 offset:0
    ds_read_b128 v[200:203], v22 offset:0
    ds_read_b128 v[204:207], v23 offset:0
    ds_read_b128 v[208:211], v20 offset:4096
    ds_read_b128 v[212:215], v21 offset:4096
    ds_read_b128 v[216:219], v22 offset:4096
    ds_read_b128 v[220:223], v23 offset:4096
L_w_23:
    s_waitcnt lgkmcnt(0)
    s_waitcnt vmcnt(3)
    s_barrier
    s_add_u32 m0, s49, 40960
    s_xor_b32 s57, s48, 172032
    buffer_load_dwordx4 v16, s[12:15], s57 offen nt lds
    s_cmp_lg_u32 s3, 1
    s_cbranch_scc1 L_w_24
    ds_read_b128 v[192:195], v20 offset:0
    ds_read_b128 v[196:199], v21 offset:0
    ds_read_b128 v[200:203], v22 offset:0
    ds_read_b128 v[204:207], v23 offset:0
    ds_read_b128 v[208:211], v20 offset:4096
    ds_read_b128 v[212:215], v21 offset:4096
    ds_read_b128 v[216:219], v22 offset:4096
    ds_read_b128 v[220:223], v23 offset:4096
L_w_24:
    s_waitcnt lgkmcnt(0)
    s_waitcnt vmcnt(3)
    s_cmp_gt_u32 s3, 1
    s_cbranch_scc1 L_fsk_27
    s_waitcnt vmcnt(4)
L_fp_25:
    v_cmp_ne_u64 vcc, s[100:101], v[26:27]
    s_cmp_eq_u64 vcc, 0
    s_cbranch_scc1 L_fok_26
    s_sleep 2
    buffer_load_dwordx3 v[26:28], v10, s[36:39], s52 offen sc1
    s_sub_u32 s51, s51, 1
    s_waitcnt vmcnt(0)
    s_cbranch_scc0 L_fp_25
    s_endpgm
L_fok_26:
    s_cmp_eq_u32 s3, 0
    s_cbranch_scc1 L_fsk_27
    s_getreg_b32 s4, hwreg(HW_REG_XCC_ID)
    v_cmp_ne_u32 vcc, s4, v28
    s_cmp_eq_u32 vcc_lo, 0
    s_cselect_b32 s4, 1, 0
    v_mov_b32 v28, 141312
    v_mov_b32 v27, s4
    ds_write_b32 v28, v27
    s_waitcnt lgkmcnt(0)
L_fsk_27:
    s_barrier
    s_add_u32 s4, s54, 0
    buffer_load_dwordx4 v[64:67], v12, s[36:39], s4 offen sc1
    s_add_u32 s4, s54, 8192
    buffer_load_dwordx4 v[68:71], v12, s[36:39], s4 offen sc1
    s_add_u32 s4, s54, 16384
    buffer_load_dwordx4 v[72:75], v12, s[36:39], s4 offen sc1
    s_add_u32 s4, s54, 24576
    buffer_load_dwordx4 v[76:79], v12, s[36:39], s4 offen sc1
    s_add_u32 m0, s49, 49152
    s_xor_b32 s57, s48, 180224
    buffer_load_dwordx4 v16, s[12:15], s57 offen nt lds
    s_cmp_lg_u32 s3, 2
    s_cbranch_scc1 L_w_28
    ds_read_b128 v[192:195], v20 offset:0
    ds_read_b128 v[196:199], v21 offset:0
    ds_read_b128 v[200:203], v22 offset:0
    ds_read_b128 v[204:207], v23 offset:0
    ds_read_b128 v[208:211], v20 offset:4096
    ds_read_b128 v[212:215], v21 offset:4096
    ds_read_b128 v[216:219], v22 offset:4096
    ds_read_b128 v[220:223], v23 offset:4096
L_w_28:
    s_waitcnt lgkmcnt(0)
    s_waitcnt vmcnt(7)
    s_barrier
    s_add_u32 m0, s49, 57344
    s_xor_b32 s57, s48, 188416
    buffer_load_dwordx4 v16, s[12:15], s57 offen nt lds
    s_add_u32 m0, s49, 0
    s_xor_b32 s57, s48, 196608
    buffer_load_dwordx4 v16, s[12:15], s57 offen nt lds
    s_add_u32 m0, s49, 8192
    s_xor_b32 s57, s48, 204800
    buffer_load_dwordx4 v16, s[12:15], s57 offen nt lds
    s_cmp_lg_u32 s3, 3
    s_cbranch_scc1 L_w_29
    ds_read_b128 v[192:195], v20 offset:0
    ds_read_b128 v[196:199], v21 offset:0
    ds_read_b128 v[200:203], v22 offset:0
    ds_read_b128 v[204:207], v23 offset:0
    ds_read_b128 v[208:211], v20 offset:4096
    ds_read_b128 v[212:215], v21 offset:4096
    ds_read_b128 v[216:219], v22 offset:4096
    ds_read_b128 v[220:223], v23 offset:4096
L_w_29:
    v_mov_b32 v28, 141312
    ds_read_b32 v28, v28
    s_waitcnt lgkmcnt(0)
    v_readfirstlane_b32 s81, v28
    s_waitcnt lgkmcnt(0)
    s_waitcnt vmcnt(9)
    s_barrier
    s_add_u32 m0, s49, 16384
    s_xor_b32 s57, s48, 212992
    buffer_load_dwordx4 v16, s[12:15], s57 offen nt lds
    s_add_u32 m0, s49, 24576
    s_xor_b32 s57, s48, 221184
    buffer_load_dwordx4 v16, s[12:15], s57 offen nt lds
    s_cmp_lg_u32 s3, 4
    s_cbranch_scc1 L_w_30
    ds_read_b128 v[192:195], v20 offset:0
    ds_read_b128 v[196:199], v21 offset:0
    ds_read_b128 v[200:203], v22 offset:0
    ds_read_b128 v[204:207], v23 offset:0
    ds_read_b128 v[208:211], v20 offset:4096
    ds_read_b128 v[212:215], v21 offset:4096
    ds_read_b128 v[216:219], v22 offset:4096
    ds_read_b128 v[220:223], v23 offset:4096
L_w_30:
    s_waitcnt lgkmcnt(0)
    s_waitcnt vmcnt(10)
    s_barrier
    s_add_u32 m0, s49, 32768
    s_xor_b32 s57, s48, 229376
    buffer_load_dwordx4 v16, s[12:15], s57 offen nt lds
    s_cmp_lg_u32 s3, 5
    s_cbranch_scc1 L_w_31
    ds_read_b128 v[192:195], v20 offset:0
    ds_read_b128 v[196:199], v21 offset:0
    ds_read_b128 v[200:203], v22 offset:0
    ds_read_b128 v[204:207], v23 offset:0
    ds_read_b128 v[208:211], v20 offset:4096
    ds_read_b128 v[212:215], v21 offset:4096
    ds_read_b128 v[216:219], v22 offset:4096
    ds_read_b128 v[220:223], v23 offset:4096
L_w_31:
    s_waitcnt lgkmcnt(0)
    s_waitcnt vmcnt(6)
    s_barrier
    s_add_u32 m0, s49, 40960
    s_xor_b32 s57, s48, 237568
    buffer_load_dwordx4 v16, s[12:15], s57 offen nt lds
    s_cmp_lg_u32 s3, 6
    s_cbranch_scc1 L_w_32
    ds_read_b128 v[192:195], v20 offset:0
    ds_read_b128 v[196:199], v21 offset:0
    ds_read_b128 v[200:203], v22 offset:0
    ds_read_b128 v[204:207], v23 offset:0
    ds_read_b128 v[208:211], v20 offset:4096
    ds_read_b128 v[212:215], v21 offset:4096
    ds_read_b128 v[216:219], v22 offset:4096
    ds_read_b128 v[220:223], v23 offset:4096
L_w_32:
    s_waitcnt vmcnt(8)
    v_lshlrev_b32 v80, 16, v64
    v_and_b32 v84, 0xffff0000, v64
    v_lshlrev_b32 v81, 16, v68
    v_and_b32 v85, 0xffff0000, v68
    v_lshlrev_b32 v82, 16, v72
    v_and_b32 v86, 0xffff0000, v72
    v_lshlrev_b32 v83, 16, v76
    v_and_b32 v87, 0xffff0000, v76
    v_add_f32 v80, v80, v81
    v_add_f32 v82, v82, v83
    v_add_f32 v84, v84, v85
    v_add_f32 v86, v86, v87
    v_add_f32 v80, v80, v82
    v_add_f32 v84, v84, v86
    v_cvt_pk_bf16_f32 v88, v80, v84
    v_lshlrev_b32 v80, 16, v65
    v_and_b32 v84, 0xffff0000, v65
    v_lshlrev_b32 v81, 16, v69
    v_and_b32 v85, 0xffff0000, v69
    v_lshlrev_b32 v82, 16, v73
    v_and_b32 v86, 0xffff0000, v73
    v_lshlrev_b32 v83, 16, v77
    v_and_b32 v87, 0xffff0000, v77
    v_add_f32 v80, v80, v81
    v_add_f32 v82, v82, v83
    v_add_f32 v84, v84, v85
    v_add_f32 v86, v86, v87
    v_add_f32 v80, v80, v82
    v_add_f32 v84, v84, v86
    v_cvt_pk_bf16_f32 v89, v80, v84
    v_lshlrev_b32 v80, 16, v66
    v_and_b32 v84, 0xffff0000, v66
    v_lshlrev_b32 v81, 16, v70
    v_and_b32 v85, 0xffff0000, v70
    v_lshlrev_b32 v82, 16, v74
    v_and_b32 v86, 0xffff0000, v74
    v_lshlrev_b32 v83, 16, v78
    v_and_b32 v87, 0xffff0000, v78
    v_add_f32 v80, v80, v81
    v_add_f32 v82, v82, v83
    v_add_f32 v84, v84, v85
    v_add_f32 v86, v86, v87
    v_add_f32 v80, v80, v82
    v_add_f32 v84, v84, v86
    v_cvt_pk_bf16_f32 v90, v80, v84
    v_lshlrev_b32 v80, 16, v67
    v_and_b32 v84, 0xffff0000, v67
    v_lshlrev_b32 v81, 16, v71
    v_and_b32 v85, 0xffff0000, v71
    v_lshlrev_b32 v82, 16, v75
    v_and_b32 v86, 0xffff0000, v75
    v_lshlrev_b32 v83, 16, v79
    v_and_b32 v87, 0xffff0000, v79
    v_add_f32 v80, v80, v81
    v_add_f32 v82, v82, v83
    v_add_f32 v84, v84, v85
    v_add_f32 v86, v86, v87
    v_add_f32 v80, v80, v82
    v_add_f32 v84, v84, v86
    v_cvt_pk_bf16_f32 v91, v80, v84
    ds_write_b128 v5, v[88:91]
    s_waitcnt lgkmcnt(0)
    s_waitcnt vmcnt(6)
    s_barrier
    s_add_u32 m0, s49, 49152
    s_xor_b32 s57, s48, 245760
    buffer_load_dwordx4 v16, s[12:15], s57 offen nt lds
    ds_read_b128 v[32:35], v1 offset:0
    ds_read_b128 v[36:39], v1 offset:1024
    ds_read_b128 v[40:43], v1 offset:2048
    ds_read_b128 v[44:47], v1 offset:3072
    ds_read_b128 v[48:51], v1 offset:4096
    ds_read_b128 v[52:55], v1 offset:5120
    ds_read_b128 v[56:59], v1 offset:6144
    ds_read_b128 v[60:63], v1 offset:7168
    s_cmp_lg_u32 s3, 7
    s_cbranch_scc1 L_w_33
    ds_read_b128 v[192:195], v20 offset:0
    ds_read_b128 v[196:199], v21 offset:0
    ds_read_b128 v[200:203], v22 offset:0
    ds_read_b128 v[204:207], v23 offset:0
    ds_read_b128 v[208:211], v20 offset:4096
    ds_read_b128 v[212:215], v21 offset:4096
    ds_read_b128 v[216:219], v22 offset:4096
    ds_read_b128 v[220:223], v23 offset:4096
L_w_33:
    s_waitcnt lgkmcnt(0)
    v_mfma_f32_16x16x32_bf16 v[64:67], v[128:131], v[32:35], 0
    v_mfma_f32_16x16x32_bf16 v[68:71], v[128:131], v[36:39], 0
    v_mfma_f32_16x16x32_bf16 v[64:67], v[132:135], v[40:43], v[64:67]
    v_mfma_f32_16x16x32_bf16 v[68:71], v[132:135], v[44:47], v[68:71]
    v_mfma_f32_16x16x32_bf16 v[64:67], v[136:139], v[48:51], v[64:67]
    v_mfma_f32_16x16x32_bf16 v[68:71], v[136:139], v[52:55], v[68:71]
    v_mfma_f32_16x16x32_bf16 v[64:67], v[140:143], v[56:59], v[64:67]
    v_mfma_f32_16x16x32_bf16 v[68:71], v[140:143], v[60:63], v[68:71]
    v_mfma_f32_16x16x32_bf16 v[72:75], v[144:147], v[32:35], 0
    v_mfma_f32_16x16x32_bf16 v[76:79], v[144:147], v[36:39], 0
    v_mfma_f32_16x16x32_bf16 v[72:75], v[148:151], v[40:43], v[72:75]
    v_mfma_f32_16x16x32_bf16 v[76:79], v[148:151], v[44:47], v[76:79]
    v_mfma_f32_16x16x32_bf16 v[72:75], v[152:155], v[48:51], v[72:75]
    v_mfma_f32_16x16x32_bf16 v[76:79], v[152:155], v[52:55], v[76:79]
    v_mfma_f32_16x16x32_bf16 v[72:75], v[156:159], v[56:59], v[72:75]
    v_mfma_f32_16x16x32_bf16 v[76:79], v[156:159], v[60:63], v[76:79]
    s_waitcnt vmcnt(6)
    s_barrier
    s_add_u32 m0, s49, 57344
    s_xor_b32 s57, s48, 253952
    buffer_load_dwordx4 v16, s[12:15], s57 offen nt lds
    s_cmp_lg_u32 s3, 0
    s_cbranch_scc1 L_w_34
    ds_read_b128 v[224:227], v20 offset:0
    ds_read_b128 v[228:231], v21 offset:0
    ds_read_b128 v[232:235], v22 offset:0
    ds_read_b128 v[236:239], v23 offset:0
    ds_read_b128 v[240:243], v20 offset:4096
    ds_read_b128 v[244:247], v21 offset:4096
    ds_read_b128 v[248:251], v22 offset:4096
    ds_read_b128 v[252:255], v23 offset:4096
L_w_34:
    s_waitcnt lgkmcnt(0)
    v_mfma_f32_16x16x32_bf16 v[80:83], v[160:163], v[32:35], 0
    v_mfma_f32_16x16x32_bf16 v[84:87], v[160:163], v[36:39], 0
    v_mfma_f32_16x16x32_bf16 v[80:83], v[164:167], v[40:43], v[80:83]
    v_mfma_f32_16x16x32_bf16 v[84:87], v[164:167], v[44:47], v[84:87]
    v_mfma_f32_16x16x32_bf16 v[80:83], v[168:171], v[48:51], v[80:83]
    v_mfma_f32_16x16x32_bf16 v[84:87], v[168:171], v[52:55], v[84:87]
    v_mfma_f32_16x16x32_bf16 v[80:83], v[172:175], v[56:59], v[80:83]
    v_mfma_f32_16x16x32_bf16 v[84:87], v[172:175], v[60:63], v[84:87]
    v_mfma_f32_16x16x32_bf16 v[88:91], v[176:179], v[32:35], 0
    v_mfma_f32_16x16x32_bf16 v[92:95], v[176:179], v[36:39], 0
    v_mfma_f32_16x16x32_bf16 v[88:91], v[180:183], v[40:43], v[88:91]
    v_mfma_f32_16x16x32_bf16 v[92:95], v[180:183], v[44:47], v[92:95]
    v_mfma_f32_16x16x32_bf16 v[88:91], v[184:187], v[48:51], v[88:91]
    v_mfma_f32_16x16x32_bf16 v[92:95], v[184:187], v[52:55], v[92:95]
    v_mfma_f32_16x16x32_bf16 v[88:91], v[188:191], v[56:59], v[88:91]
    v_mfma_f32_16x16x32_bf16 v[92:95], v[188:191], v[60:63], v[92:95]
    v_max3_f32 v24, v64, v65, v66
    v_max_f32 v24, v24, v67
    v_max3_f32 v25, v68, v69, v70
    v_max_f32 v25, v25, v71
    v_max3_f32 v24, v24, v72, v73
    v_max3_f32 v24, v24, v74, v75
    v_max3_f32 v25, v25, v76, v77
    v_max3_f32 v25, v25, v78, v79
    s_waitcnt vmcnt(6)
    s_barrier
    s_add_u32 m0, s49, 0
    s_xor_b32 s57, s48, 0
    buffer_load_dwordx4 v2, s[16:19], s57 offen nt lds
    s_cmp_lg_u32 s3, 1
    s_cbranch_scc1 L_w_35
    ds_read_b128 v[224:227], v20 offset:0
    ds_read_b128 v[228:231], v21 offset:0
    ds_read_b128 v[232:235], v22 offset:0
    ds_read_b128 v[236:239], v23 offset:0
    ds_read_b128 v[240:243], v20 offset:4096
    ds_read_b128 v[244:247], v21 offset:4096
    ds_read_b128 v[248:251], v22 offset:4096
    ds_read_b128 v[252:255], v23 offset:4096
L_w_35:
    s_waitcnt lgkmcnt(0)
    v_mfma_f32_16x16x32_bf16 v[96:99], v[192:195], v[32:35], 0
    v_mfma_f32_16x16x32_bf16 v[100:103], v[192:195], v[36:39], 0
    v_mfma_f32_16x16x32_bf16 v[96:99], v[196:199], v[40:43], v[96:99]
    v_mfma_f32_16x16x32_bf16 v[100:103], v[196:199], v[44:47], v[100:103]
    v_mfma_f32_16x16x32_bf16 v[96:99], v[200:203], v[48:51], v[96:99]
    v_mfma_f32_16x16x32_bf16 v[100:103], v[200:203], v[52:55], v[100:103]
    v_mfma_f32_16x16x32_bf16 v[96:99], v[204:207], v[56:59], v[96:99]
    v_mfma_f32_16x16x32_bf16 v[100:103], v[204:207], v[60:63], v[100:103]
    v_mfma_f32_16x16x32_bf16 v[104:107], v[208:211], v[32:35], 0
    v_mfma_f32_16x16x32_bf16 v[108:111], v[208:211], v[36:39], 0
    v_mfma_f32_16x16x32_bf16 v[104:107], v[212:215], v[40:43], v[104:107]
    v_mfma_f32_16x16x32_bf16 v[108:111], v[212:215], v[44:47], v[108:111]
    v_mfma_f32_16x16x32_bf16 v[104:107], v[216:219], v[48:51], v[104:107]
    v_mfma_f32_16x16x32_bf16 v[108:111], v[216:219], v[52:55], v[108:111]
    v_mfma_f32_16x16x32_bf16 v[104:107], v[220:223], v[56:59], v[104:107]
    v_mfma_f32_16x16x32_bf16 v[108:111], v[220:223], v[60:63], v[108:111]
    v_max3_f32 v24, v24, v80, v81
    v_max3_f32 v24, v24, v82, v83
    v_max3_f32 v25, v25, v84, v85
    v_max3_f32 v25, v25, v86, v87
    v_max3_f32 v24, v24, v88, v89
    v_max3_f32 v24, v24, v90, v91
    v_max3_f32 v25, v25, v92, v93
    v_max3_f32 v25, v25, v94, v95
    s_waitcnt vmcnt(6)
    s_barrier
    s_add_u32 m0, s49, 8192
    s_xor_b32 s57, s48, 8192
    buffer_load_dwordx4 v2, s[16:19], s57 offen nt lds
    s_cmp_lg_u32 s3, 2
    s_cbranch_scc1 L_w_36
    ds_read_b128 v[224:227], v20 offset:0
    ds_read_b128 v[228:231], v21 offset:0
    ds_read_b128 v[232:235], v22 offset:0
    ds_read_b128 v[236:239], v23 offset:0
    ds_read_b128 v[240:243], v20 offset:4096
    ds_read_b128 v[244:247], v21 offset:4096
    ds_read_b128 v[248:251], v22 offset:4096
    ds_read_b128 v[252:255], v23 offset:4096
L_w_36:
    s_waitcnt lgkmcnt(0)
    v_max3_f32 v24, v24, v96, v97
    v_max3_f32 v24, v24, v98, v99
    v_max3_f32 v25, v25, v100, v101
    v_max3_f32 v25, v25, v102, v103
    v_max3_f32 v24, v24, v104, v105
    v_max3_f32 v24, v24, v106, v107
    v_max3_f32 v25, v25, v108, v109
    v_max3_f32 v25, v25, v110, v111
    s_cmp_gt_u32 s3, 2
    s_cbranch_scc1 L_w_37
    v_mfma_f32_16x16x32_bf16 v[112:115], v[224:227], v[32:35], 0
    v_mfma_f32_16x16x32_bf16 v[116:119], v[224:227], v[36:39], 0
    v_mfma_f32_16x16x32_bf16 v[112:115], v[228:231], v[40:43], v[112:115]
    v_mfma_f32_16x16x32_bf16 v[116:119], v[228:231], v[44:47], v[116:119]
    v_mfma_f32_16x16x32_bf16 v[112:115], v[232:235], v[48:51], v[112:115]
    v_mfma_f32_16x16x32_bf16 v[116:119], v[232:235], v[52:55], v[116:119]
    v_mfma_f32_16x16x32_bf16 v[112:115], v[236:239], v[56:59], v[112:115]
    v_mfma_f32_16x16x32_bf16 v[116:119], v[236:239], v[60:63], v[116:119]
    v_mfma_f32_16x16x32_bf16 v[120:123], v[240:243], v[32:35], 0
    v_mfma_f32_16x16x32_bf16 v[124:127], v[240:243], v[36:39], 0
    v_mfma_f32_16x16x32_bf16 v[120:123], v[244:247], v[40:43], v[120:123]
    v_mfma_f32_16x16x32_bf16 v[124:127], v[244:247], v[44:47], v[124:127]
    v_mfma_f32_16x16x32_bf16 v[120:123], v[248:251], v[48:51], v[120:123]
    v_mfma_f32_16x16x32_bf16 v[124:127], v[248:251], v[52:55], v[124:127]
    v_mfma_f32_16x16x32_bf16 v[120:123], v[252:255], v[56:59], v[120:123]
    v_mfma_f32_16x16x32_bf16 v[124:127], v[252:255], v[60:63], v[124:127]
L_w_37:
    s_waitcnt vmcnt(6)
    s_barrier
    s_add_u32 m0, s49, 16384
    s_xor_b32 s57, s48, 16384
    buffer_load_dwordx4 v2, s[16:19], s57 offen nt lds
    s_cmp_lg_u32 s3, 3
    s_cbranch_scc1 L_w_38
    ds_read_b128 v[224:227], v20 offset:0
    ds_read_b128 v[228:231], v21 offset:0
    ds_read_b128 v[232:235], v22 offset:0
    ds_read_b128 v[236:239], v23 offset:0
    ds_read_b128 v[240:243], v20 offset:4096
    ds_read_b128 v[244:247], v21 offset:4096
    ds_read_b128 v[248:251], v22 offset:4096
    ds_read_b128 v[252:255], v23 offset:4096
    s_waitcnt lgkmcnt(0)
    v_mfma_f32_16x16x32_bf16 v[112:115], v[224:227], v[32:35], 0
    v_mfma_f32_16x16x32_bf16 v[116:119], v[224:227], v[36:39], 0
    v_mfma_f32_16x16x32_bf16 v[112:115], v[228:231], v[40:43], v[112:115]
    v_mfma_f32_16x16x32_bf16 v[116:119], v[228:231], v[44:47], v[116:119]
    v_mfma_f32_16x16x32_bf16 v[112:115], v[232:235], v[48:51], v[112:115]
    v_mfma_f32_16x16x32_bf16 v[116:119], v[232:235], v[52:55], v[116:119]
    v_mfma_f32_16x16x32_bf16 v[112:115], v[236:239], v[56:59], v[112:115]
    v_mfma_f32_16x16x32_bf16 v[116:119], v[236:239], v[60:63], v[116:119]
    v_mfma_f32_16x16x32_bf16 v[120:123], v[240:243], v[32:35], 0
    v_mfma_f32_16x16x32_bf16 v[124:127], v[240:243], v[36:39], 0
    v_mfma_f32_16x16x32_bf16 v[120:123], v[244:247], v[40:43], v[120:123]
    v_mfma_f32_16x16x32_bf16 v[124:127], v[244:247], v[44:47], v[124:127]
    v_mfma_f32_16x16x32_bf16 v[120:123], v[248:251], v[48:51], v[120:123]
    v_mfma_f32_16x16x32_bf16 v[124:127], v[248:251], v[52:55], v[124:127]
    v_mfma_f32_16x16x32_bf16 v[120:123], v[252:255], v[56:59], v[120:123]
    v_mfma_f32_16x16x32_bf16 v[124:127], v[252:255], v[60:63], v[124:127]
L_w_38:
    s_waitcnt lgkmcnt(0)
    s_waitcnt vmcnt(6)
    s_barrier
    s_add_u32 m0, s49, 24576
    s_xor_b32 s57, s48, 24576
    buffer_load_dwordx4 v2, s[16:19], s57 offen nt lds
    s_cmp_lg_u32 s3, 4
    s_cbranch_scc1 L_w_39
    ds_read_b128 v[224:227], v20 offset:0
    ds_read_b128 v[228:231], v21 offset:0
    ds_read_b128 v[232:235], v22 offset:0
    ds_read_b128 v[236:239], v23 offset:0
    ds_read_b128 v[240:243], v20 offset:4096
    ds_read_b128 v[244:247], v21 offset:4096
    ds_read_b128 v[248:251], v22 offset:4096
    ds_read_b128 v[252:255], v23 offset:4096
    s_waitcnt lgkmcnt(0)
    v_mfma_f32_16x16x32_bf16 v[112:115], v[224:227], v[32:35], 0
    v_mfma_f32_16x16x32_bf16 v[116:119], v[224:227], v[36:39], 0
    v_mfma_f32_16x16x32_bf16 v[112:115], v[228:231], v[40:43], v[112:115]
    v_mfma_f32_16x16x32_bf16 v[116:119], v[228:231], v[44:47], v[116:119]
    v_mfma_f32_16x16x32_bf16 v[112:115], v[232:235], v[48:51], v[112:115]
    v_mfma_f32_16x16x32_bf16 v[116:119], v[232:235], v[52:55], v[116:119]
    v_mfma_f32_16x16x32_bf16 v[112:115], v[236:239], v[56:59], v[112:115]
    v_mfma_f32_16x16x32_bf16 v[116:119], v[236:239], v[60:63], v[116:119]
    v_mfma_f32_16x16x32_bf16 v[120:123], v[240:243], v[32:35], 0
    v_mfma_f32_16x16x32_bf16 v[124:127], v[240:243], v[36:39], 0
    v_mfma_f32_16x16x32_bf16 v[120:123], v[244:247], v[40:43], v[120:123]
    v_mfma_f32_16x16x32_bf16 v[124:127], v[244:247], v[44:47], v[124:127]
    v_mfma_f32_16x16x32_bf16 v[120:123], v[248:251], v[48:51], v[120:123]
    v_mfma_f32_16x16x32_bf16 v[124:127], v[248:251], v[52:55], v[124:127]
    v_mfma_f32_16x16x32_bf16 v[120:123], v[252:255], v[56:59], v[120:123]
    v_mfma_f32_16x16x32_bf16 v[124:127], v[252:255], v[60:63], v[124:127]
L_w_39:
    s_waitcnt lgkmcnt(0)
    s_waitcnt vmcnt(6)
    s_barrier
    s_add_u32 m0, s49, 32768
    s_xor_b32 s57, s48, 32768
    buffer_load_dwordx4 v2, s[16:19], s57 offen nt lds
    s_cmp_lg_u32 s3, 5
    s_cbranch_scc1 L_w_40
    ds_read_b128 v[224:227], v20 offset:0
    ds_read_b128 v[228:231], v21 offset:0
    ds_read_b128 v[232:235], v22 offset:0
    ds_read_b128 v[236:239], v23 offset:0
    ds_read_b128 v[240:243], v20 offset:4096
    ds_read_b128 v[244:247], v21 offset:4096
    ds_read_b128 v[248:251], v22 offset:4096
    ds_read_b128 v[252:255], v23 offset:4096
    s_waitcnt lgkmcnt(0)
    v_mfma_f32_16x16x32_bf16 v[112:115], v[224:227], v[32:35], 0
    v_mfma_f32_16x16x32_bf16 v[116:119], v[224:227], v[36:39], 0
    v_mfma_f32_16x16x32_bf16 v[112:115], v[228:231], v[40:43], v[112:115]
    v_mfma_f32_16x16x32_bf16 v[116:119], v[228:231], v[44:47], v[116:119]
    v_mfma_f32_16x16x32_bf16 v[112:115], v[232:235], v[48:51], v[112:115]
    v_mfma_f32_16x16x32_bf16 v[116:119], v[232:235], v[52:55], v[116:119]
    v_mfma_f32_16x16x32_bf16 v[112:115], v[236:239], v[56:59], v[112:115]
    v_mfma_f32_16x16x32_bf16 v[116:119], v[236:239], v[60:63], v[116:119]
    v_mfma_f32_16x16x32_bf16 v[120:123], v[240:243], v[32:35], 0
    v_mfma_f32_16x16x32_bf16 v[124:127], v[240:243], v[36:39], 0
    v_mfma_f32_16x16x32_bf16 v[120:123], v[244:247], v[40:43], v[120:123]
    v_mfma_f32_16x16x32_bf16 v[124:127], v[244:247], v[44:47], v[124:127]
    v_mfma_f32_16x16x32_bf16 v[120:123], v[248:251], v[48:51], v[120:123]
    v_mfma_f32_16x16x32_bf16 v[124:127], v[248:251], v[52:55], v[124:127]
    v_mfma_f32_16x16x32_bf16 v[120:123], v[252:255], v[56:59], v[120:123]
    v_mfma_f32_16x16x32_bf16 v[124:127], v[252:255], v[60:63], v[124:127]
L_w_40:
    s_waitcnt lgkmcnt(0)
    s_waitcnt vmcnt(6)
    s_barrier
    s_add_u32 m0, s49, 40960
    s_xor_b32 s57, s48, 40960
    buffer_load_dwordx4 v2, s[16:19], s57 offen nt lds
    s_cmp_lg_u32 s3, 6
    s_cbranch_scc1 L_w_41
    ds_read_b128 v[224:227], v20 offset:0
    ds_read_b128 v[228:231], v21 offset:0
    ds_read_b128 v[232:235], v22 offset:0
    ds_read_b128 v[236:239], v23 offset:0
    ds_read_b128 v[240:243], v20 offset:4096
    ds_read_b128 v[244:247], v21 offset:4096
    ds_read_b128 v[248:251], v22 offset:4096
    ds_read_b128 v[252:255], v23 offset:4096
    s_waitcnt lgkmcnt(0)
    v_mfma_f32_16x16x32_bf16 v[112:115], v[224:227], v[32:35], 0
    v_mfma_f32_16x16x32_bf16 v[116:119], v[224:227], v[36:39], 0
    v_mfma_f32_16x16x32_bf16 v[112:115], v[228:231], v[40:43], v[112:115]
    v_mfma_f32_16x16x32_bf16 v[116:119], v[228:231], v[44:47], v[116:119]
    v_mfma_f32_16x16x32_bf16 v[112:115], v[232:235], v[48:51], v[112:115]
    v_mfma_f32_16x16x32_bf16 v[116:119], v[232:235], v[52:55], v[116:119]
    v_mfma_f32_16x16x32_bf16 v[112:115], v[236:239], v[56:59], v[112:115]
    v_mfma_f32_16x16x32_bf16 v[116:119], v[236:239], v[60:63], v[116:119]
    v_mfma_f32_16x16x32_bf16 v[120:123], v[240:243], v[32:35], 0
    v_mfma_f32_16x16x32_bf16 v[124:127], v[240:243], v[36:39], 0
    v_mfma_f32_16x16x32_bf16 v[120:123], v[244:247], v[40:43], v[120:123]
    v_mfma_f32_16x16x32_bf16 v[124:127], v[244:247], v[44:47], v[124:127]
    v_mfma_f32_16x16x32_bf16 v[120:123], v[248:251], v[48:51], v[120:123]
    v_mfma_f32_16x16x32_bf16 v[124:127], v[248:251], v[52:55], v[124:127]
    v_mfma_f32_16x16x32_bf16 v[120:123], v[252:255], v[56:59], v[120:123]
    v_mfma_f32_16x16x32_bf16 v[124:127], v[252:255], v[60:63], v[124:127]
L_w_41:
    s_waitcnt lgkmcnt(0)
    s_waitcnt vmcnt(6)
    s_barrier
    s_add_u32 m0, s49, 49152
    s_xor_b32 s57, s48, 49152
    buffer_load_dwordx4 v2, s[16:19], s57 offen nt lds
    s_cmp_lg_u32 s3, 7
    s_cbranch_scc1 L_w_42
    ds_read_b128 v[224:227], v20 offset:0
    ds_read_b128 v[228:231], v21 offset:0
    ds_read_b128 v[232:235], v22 offset:0
    ds_read_b128 v[236:239], v23 offset:0
    ds_read_b128 v[240:243], v20 offset:4096
    ds_read_b128 v[244:247], v21 offset:4096
    ds_read_b128 v[248:251], v22 offset:4096
    ds_read_b128 v[252:255], v23 offset:4096
    s_waitcnt lgkmcnt(0)
    v_mfma_f32_16x16x32_bf16 v[112:115], v[224:227], v[32:35], 0
    v_mfma_f32_16x16x32_bf16 v[116:119], v[224:227], v[36:39], 0
    v_mfma_f32_16x16x32_bf16 v[112:115], v[228:231], v[40:43], v[112:115]
    v_mfma_f32_16x16x32_bf16 v[116:119], v[228:231], v[44:47], v[116:119]
    v_mfma_f32_16x16x32_bf16 v[112:115], v[232:235], v[48:51], v[112:115]
    v_mfma_f32_16x16x32_bf16 v[116:119], v[232:235], v[52:55], v[116:119]
    v_mfma_f32_16x16x32_bf16 v[112:115], v[236:239], v[56:59], v[112:115]
    v_mfma_f32_16x16x32_bf16 v[116:119], v[236:239], v[60:63], v[116:119]
    v_mfma_f32_16x16x32_bf16 v[120:123], v[240:243], v[32:35], 0
    v_mfma_f32_16x16x32_bf16 v[124:127], v[240:243], v[36:39], 0
    v_mfma_f32_16x16x32_bf16 v[120:123], v[244:247], v[40:43], v[120:123]
    v_mfma_f32_16x16x32_bf16 v[124:127], v[244:247], v[44:47], v[124:127]
    v_mfma_f32_16x16x32_bf16 v[120:123], v[248:251], v[48:51], v[120:123]
    v_mfma_f32_16x16x32_bf16 v[124:127], v[248:251], v[52:55], v[124:127]
    v_mfma_f32_16x16x32_bf16 v[120:123], v[252:255], v[56:59], v[120:123]
    v_mfma_f32_16x16x32_bf16 v[124:127], v[252:255], v[60:63], v[124:127]
L_w_42:
    s_waitcnt lgkmcnt(0)
    s_nop 7
    v_max3_f32 v24, v24, v112, v113
    v_max3_f32 v24, v24, v114, v115
    v_max3_f32 v25, v25, v116, v117
    v_max3_f32 v25, v25, v118, v119
    v_max3_f32 v24, v24, v120, v121
    v_max3_f32 v24, v24, v122, v123
    v_max3_f32 v25, v25, v124, v125
    v_max3_f32 v25, v25, v126, v127
    s_nop 1
    v_permlane16_swap_b32 v24, v25
    s_nop 0
    v_max_f32 v24, v24, v25
    v_mov_b32 v25, v24
    s_nop 1
    v_permlane32_swap_b32 v24, v25
    s_nop 0
    v_max_f32 v24, v24, v25
    ds_write_b32 v18, v24
    s_waitcnt lgkmcnt(0)
    s_barrier
    ds_read_b128 v[32:35], v19 offset:0
    ds_read_b128 v[36:39], v19 offset:16
    ds_read_b128 v[40:43], v19 offset:512
    ds_read_b128 v[44:47], v19 offset:528
    v_mov_b32 v48, 0
    v_mov_b32 v49, 0
    s_waitcnt lgkmcnt(0)
    v_max3_f32 v24, v32, v33, v34
    v_max3_f32 v24, v24, v35, v36
    v_max3_f32 v24, v24, v37, v38
    v_max_f32 v24, v24, v39
    v_mul_f32 v24, s50, v24
    v_max3_f32 v25, v40, v41, v42
    v_max3_f32 v25, v25, v43, v44
    v_max3_f32 v25, v25, v45, v46
    v_max_f32 v25, v25, v47
    v_mul_f32 v25, s50, v25
    v_fma_f32 v64, v64, s50, -v24
    v_fma_f32 v65, v65, s50, -v24
    v_fma_f32 v66, v66, s50, -v24
    v_fma_f32 v67, v67, s50, -v24
    v_fma_f32 v72, v72, s50, -v24
    v_fma_f32 v73, v73, s50, -v24
    v_fma_f32 v74, v74, s50, -v24
    v_fma_f32 v75, v75, s50, -v24
    v_exp_f32 v64, v64
    v_exp_f32 v65, v65
    v_exp_f32 v66, v66
    v_exp_f32 v67, v67
    v_exp_f32 v72, v72
    v_exp_f32 v73, v73
    v_exp_f32 v74, v74
    v_exp_f32 v75, v75
    s_nop 0
    v_cvt_pk_bf16_f32 v32, v64, v65
    v_cvt_pk_bf16_f32 v33, v66, v67
    v_cvt_pk_bf16_f32 v34, v72, v73
    v_cvt_pk_bf16_f32 v35, v74, v75
    ds_write_b128 v31, v[32:35] offset:0
    v_add_f32 v50, v64, v65
    v_add_f32 v51, v66, v67
    v_add_f32 v52, v72, v73
    v_add_f32 v53, v74, v75
    v_add_f32 v50, v50, v51
    v_add_f32 v52, v52, v53
    v_add_f32 v50, v50, v52
    v_add_f32 v48, v48, v50
    s_add_u32 m0, s49, 57344
    s_xor_b32 s57, s48, 57344
    buffer_load_dwordx4 v2, s[16:19], s57 offen nt lds
    v_fma_f32 v68, v68, s50, -v25
    v_fma_f32 v69, v69, s50, -v25
    v_fma_f32 v70, v70, s50, -v25
    v_fma_f32 v71, v71, s50, -v25
    v_fma_f32 v76, v76, s50, -v25
    v_fma_f32 v77, v77, s50, -v25
    v_fma_f32 v78, v78, s50, -v25
    v_fma_f32 v79, v79, s50, -v25
    v_exp_f32 v68, v68
    v_exp_f32 v69, v69
    v_exp_f32 v70, v70
    v_exp_f32 v71, v71
    v_exp_f32 v76, v76
    v_exp_f32 v77, v77
    v_exp_f32 v78, v78
    v_exp_f32 v79, v79
    s_nop 0
    v_cvt_pk_bf16_f32 v36, v68, v69
    v_cvt_pk_bf16_f32 v37, v70, v71
    v_cvt_pk_bf16_f32 v38, v76, v77
    v_cvt_pk_bf16_f32 v39, v78, v79
    ds_write_b128 v31, v[36:39] offset:1024
    v_add_f32 v50, v68, v69
    v_add_f32 v51, v70, v71
    v_add_f32 v52, v76, v77
    v_add_f32 v53, v78, v79
    v_add_f32 v50, v50, v51
    v_add_f32 v52, v52, v53
    v_add_f32 v50, v50, v52
    v_add_f32 v49, v49, v50
    v_mov_b32 v56, 0
    v_mov_b32 v57, 0
    v_mov_b32 v58, 0
    v_mov_b32 v59, 0
    v_mov_b32 v60, 0
    v_mov_b32 v61, 0
    v_mov_b32 v62, 0
    v_mov_b32 v63, 0
    s_waitcnt lgkmcnt(0)
    s_waitcnt vmcnt(7)
    s_barrier
    ds_read_b128 v[192:195], v3 offset:0
    ds_read_b128 v[196:199], v3 offset:1024
    ds_read_b64_tr_b16 v[208:209], v4 offset:0
    ds_read_b64_tr_b16 v[210:211], v4 offset:4096
    ds_read_b128 v[200:203], v3 offset:2048
    ds_read_b128 v[204:207], v3 offset:3072
    v_mov_b32 v236, -1
    v_mov_b32 v237, -1
    v_mov_b32 v238, -1
    v_mov_b32 v239, -1
    s_cmp_eq_u32 s81, 0
    s_cbranch_scc1 L_dev_43
    buffer_store_dwordx4 v[236:239], v3, s[36:39], s59 offen
    s_branch L_st_44
L_dev_43:
    buffer_store_dwordx4 v[236:239], v3, s[36:39], s59 offen sc1
L_st_44:
    s_waitcnt lgkmcnt(2)
    v_mfma_f32_16x16x32_bf16 v[56:59], v[208:211], v[192:195], v[56:59]
    v_mfma_f32_16x16x32_bf16 v[60:63], v[208:211], v[196:199], v[60:63]
    v_fma_f32 v80, v80, s50, -v24
    v_fma_f32 v81, v81, s50, -v24
    v_fma_f32 v82, v82, s50, -v24
    v_fma_f32 v83, v83, s50, -v24
    v_fma_f32 v88, v88, s50, -v24
    v_fma_f32 v89, v89, s50, -v24
    v_fma_f32 v90, v90, s50, -v24
    v_fma_f32 v91, v91, s50, -v24
    v_exp_f32 v80, v80
    v_exp_f32 v81, v81
    v_exp_f32 v82, v82
    v_exp_f32 v83, v83
    v_exp_f32 v88, v88
    v_exp_f32 v89, v89
    v_exp_f32 v90, v90
    v_exp_f32 v91, v91
    s_nop 0
    v_cvt_pk_bf16_f32 v40, v80, v81
    v_cvt_pk_bf16_f32 v41, v82, v83
    v_cvt_pk_bf16_f32 v42, v88, v89
    v_cvt_pk_bf16_f32 v43, v90, v91
    ds_write_b128 v31, v[40:43] offset:16384
    v_add_f32 v50, v80, v81
    v_add_f32 v51, v82, v83
    v_add_f32 v52, v88, v89
    v_add_f32 v53, v90, v91
    v_add_f32 v50, v50, v51
    v_add_f32 v52, v52, v53
    v_add_f32 v50, v50, v52
    v_add_f32 v48, v48, v50
    s_waitcnt vmcnt(7)
    s_barrier
    ds_read_b64_tr_b16 v[212:213], v4 offset:8192
    ds_read_b64_tr_b16 v[214:215], v4 offset:12288
    ds_read_b128 v[192:195], v3 offset:4096
    ds_read_b128 v[196:199], v3 offset:5120
    s_add_u32 m0, s49, 0
    s_xor_b32 s57, s48, 65536
    buffer_load_dwordx4 v2, s[16:19], s57 offen nt lds
    s_waitcnt lgkmcnt(2)
    v_mfma_f32_16x16x32_bf16 v[56:59], v[212:215], v[200:203], v[56:59]
    v_mfma_f32_16x16x32_bf16 v[60:63], v[212:215], v[204:207], v[60:63]
    v_fma_f32 v84, v84, s50, -v25
    v_fma_f32 v85, v85, s50, -v25
    v_fma_f32 v86, v86, s50, -v25
    v_fma_f32 v87, v87, s50, -v25
    v_fma_f32 v92, v92, s50, -v25
    v_fma_f32 v93, v93, s50, -v25
    v_fma_f32 v94, v94, s50, -v25
    v_fma_f32 v95, v95, s50, -v25
    v_exp_f32 v84, v84
    v_exp_f32 v85, v85
    v_exp_f32 v86, v86
    v_exp_f32 v87, v87
    v_exp_f32 v92, v92
    v_exp_f32 v93, v93
    v_exp_f32 v94, v94
    v_exp_f32 v95, v95
    s_nop 0
    v_cvt_pk_bf16_f32 v44, v84, v85
    v_cvt_pk_bf16_f32 v45, v86, v87
    v_cvt_pk_bf16_f32 v46, v92, v93
    v_cvt_pk_bf16_f32 v47, v94, v95
    ds_write_b128 v31, v[44:47] offset:17408
    v_add_f32 v50, v84, v85
    v_add_f32 v51, v86, v87
    v_add_f32 v52, v92, v93
    v_add_f32 v53, v94, v95
    v_add_f32 v50, v50, v51
    v_add_f32 v52, v52, v53
    v_add_f32 v50, v50, v52
    v_add_f32 v49, v49, v50
    s_waitcnt vmcnt(7)
    s_barrier
    ds_read_b64_tr_b16 v[208:209], v4 offset:16384
    ds_read_b64_tr_b16 v[210:211], v4 offset:20480
    ds_read_b128 v[200:203], v3 offset:6144
    ds_read_b128 v[204:207], v3 offset:7168
    s_add_u32 m0, s49, 8192
    s_xor_b32 s57, s48, 73728
    buffer_load_dwordx4 v2, s[16:19], s57 offen nt lds
    s_waitcnt lgkmcnt(2)
    v_mfma_f32_16x16x32_bf16 v[56:59], v[208:211], v[192:195], v[56:59]
    v_mfma_f32_16x16x32_bf16 v[60:63], v[208:211], v[196:199], v[60:63]
    v_fma_f32 v96, v96, s50, -v24
    v_fma_f32 v97, v97, s50, -v24
    v_fma_f32 v98, v98, s50, -v24
    v_fma_f32 v99, v99, s50, -v24
    v_fma_f32 v104, v104, s50, -v24
    v_fma_f32 v105, v105, s50, -v24
    v_fma_f32 v106, v106, s50, -v24
    v_fma_f32 v107, v107, s50, -v24
    v_exp_f32 v96, v96
    v_exp_f32 v97, v97
    v_exp_f32 v98, v98
    v_exp_f32 v99, v99
    v_exp_f32 v104, v104
    v_exp_f32 v105, v105
    v_exp_f32 v106, v106
    v_exp_f32 v107, v107
    s_nop 0
    v_cvt_pk_bf16_f32 v32, v96, v97
    v_cvt_pk_bf16_f32 v33, v98, v99
    v_cvt_pk_bf16_f32 v34, v104, v105
    v_cvt_pk_bf16_f32 v35, v106, v107
    ds_write_b128 v31, v[32:35] offset:32768
    v_add_f32 v50, v96, v97
    v_add_f32 v51, v98, v99
    v_add_f32 v52, v104, v105
    v_add_f32 v53, v106, v107
    v_add_f32 v50, v50, v51
    v_add_f32 v52, v52, v53
    v_add_f32 v50, v50, v52
    v_add_f32 v48, v48, v50
    s_waitcnt vmcnt(7)
    s_barrier
    ds_read_b64_tr_b16 v[212:213], v4 offset:24576
    ds_read_b64_tr_b16 v[214:215], v4 offset:28672
    ds_read_b128 v[192:195], v3 offset:8192
    ds_read_b128 v[196:199], v3 offset:9216
    s_add_u32 m0, s49, 16384
    s_xor_b32 s57, s48, 81920
    buffer_load_dwordx4 v2, s[16:19], s57 offen nt lds
    s_waitcnt lgkmcnt(2)
    v_mfma_f32_16x16x32_bf16 v[56:59], v[212:215], v[200:203], v[56:59]
    v_mfma_f32_16x16x32_bf16 v[60:63], v[212:215], v[204:207], v[60:63]
    v_fma_f32 v100, v100, s50, -v25
    v_fma_f32 v101, v101, s50, -v25
    v_fma_f32 v102, v102, s50, -v25
    v_fma_f32 v103, v103, s50, -v25
    v_fma_f32 v108, v108, s50, -v25
    v_fma_f32 v109, v109, s50, -v25
    v_fma_f32 v110, v110, s50, -v25
    v_fma_f32 v111, v111, s50, -v25
    v_exp_f32 v100, v100
    v_exp_f32 v101, v101
    v_exp_f32 v102, v102
    v_exp_f32 v103, v103
    v_exp_f32 v108, v108
    v_exp_f32 v109, v109
    v_exp_f32 v110, v110
    v_exp_f32 v111, v111
    s_nop 0
    v_cvt_pk_bf16_f32 v36, v100, v101
    v_cvt_pk_bf16_f32 v37, v102, v103
    v_cvt_pk_bf16_f32 v38, v108, v109
    v_cvt_pk_bf16_f32 v39, v110, v111
    ds_write_b128 v31, v[36:39] offset:33792
    v_add_f32 v50, v100, v101
    v_add_f32 v51, v102, v103
    v_add_f32 v52, v108, v109
    v_add_f32 v53, v110, v111
    v_add_f32 v50, v50, v51
    v_add_f32 v52, v52, v53
    v_add_f32 v50, v50, v52
    v_add_f32 v49, v49, v50
    s_waitcnt vmcnt(7)
    s_barrier
    ds_read_b64_tr_b16 v[208:209], v4 offset:32768
    ds_read_b64_tr_b16 v[210:211], v4 offset:36864
    ds_read_b128 v[200:203], v3 offset:10240
    ds_read_b128 v[204:207], v3 offset:11264
    s_add_u32 m0, s49, 24576
    s_xor_b32 s57, s48, 90112
    buffer_load_dwordx4 v2, s[16:19], s57 offen nt lds
    s_waitcnt lgkmcnt(2)
    v_mfma_f32_16x16x32_bf16 v[56:59], v[208:211], v[192:195], v[56:59]
    v_mfma_f32_16x16x32_bf16 v[60:63], v[208:211], v[196:199], v[60:63]
    v_fma_f32 v112, v112, s50, -v24
    v_fma_f32 v113, v113, s50, -v24
    v_fma_f32 v114, v114, s50, -v24
    v_fma_f32 v115, v115, s50, -v24
    v_fma_f32 v120, v120, s50, -v24
    v_fma_f32 v121, v121, s50, -v24
    v_fma_f32 v122, v122, s50, -v24
    v_fma_f32 v123, v123, s50, -v24
    v_exp_f32 v112, v112
    v_exp_f32 v113, v113
    v_exp_f32 v114, v114
    v_exp_f32 v115, v115
    v_exp_f32 v120, v120
    v_exp_f32 v121, v121
    v_exp_f32 v122, v122
    v_exp_f32 v123, v123
    s_nop 0
    v_cvt_pk_bf16_f32 v40, v112, v113
    v_cvt_pk_bf16_f32 v41, v114, v115
    v_cvt_pk_bf16_f32 v42, v120, v121
    v_cvt_pk_bf16_f32 v43, v122, v123
    ds_write_b128 v31, v[40:43] offset:49152
    v_add_f32 v50, v112, v113
    v_add_f32 v51, v114, v115
    v_add_f32 v52, v120, v121
    v_add_f32 v53, v122, v123
    v_add_f32 v50, v50, v51
    v_add_f32 v52, v52, v53
    v_add_f32 v50, v50, v52
    v_add_f32 v48, v48, v50
    s_waitcnt vmcnt(7)
    s_barrier
    ds_read_b64_tr_b16 v[212:213], v4 offset:40960
    ds_read_b64_tr_b16 v[214:215], v4 offset:45056
    ds_read_b128 v[192:195], v3 offset:12288
    ds_read_b128 v[196:199], v3 offset:13312
    s_add_u32 m0, s49, 32768
    s_xor_b32 s57, s48, 98304
    buffer_load_dwordx4 v2, s[16:19], s57 offen nt lds
    s_waitcnt lgkmcnt(2)
    v_mfma_f32_16x16x32_bf16 v[56:59], v[212:215], v[200:203], v[56:59]
    v_mfma_f32_16x16x32_bf16 v[60:63], v[212:215], v[204:207], v[60:63]
    v_fma_f32 v116, v116, s50, -v25
    v_fma_f32 v117, v117, s50, -v25
    v_fma_f32 v118, v118, s50, -v25
    v_fma_f32 v119, v119, s50, -v25
    v_fma_f32 v124, v124, s50, -v25
    v_fma_f32 v125, v125, s50, -v25
    v_fma_f32 v126, v126, s50, -v25
    v_fma_f32 v127, v127, s50, -v25
    v_exp_f32 v116, v116
    v_exp_f32 v117, v117
    v_exp_f32 v118, v118
    v_exp_f32 v119, v119
    v_exp_f32 v124, v124
    v_exp_f32 v125, v125
    v_exp_f32 v126, v126
    v_exp_f32 v127, v127
    s_nop 0
    v_cvt_pk_bf16_f32 v44, v116, v117
    v_cvt_pk_bf16_f32 v45, v118, v119
    v_cvt_pk_bf16_f32 v46, v124, v125
    v_cvt_pk_bf16_f32 v47, v126, v127
    ds_write_b128 v31, v[44:47] offset:50176
    v_add_f32 v50, v116, v117
    v_add_f32 v51, v118, v119
    v_add_f32 v52, v124, v125
    v_add_f32 v53, v126, v127
    v_add_f32 v50, v50, v51
    v_add_f32 v52, v52, v53
    v_add_f32 v50, v50, v52
    v_add_f32 v49, v49, v50
    s_waitcnt vmcnt(7)
    s_barrier
    ds_read_b64_tr_b16 v[208:209], v4 offset:49152
    ds_read_b64_tr_b16 v[210:211], v4 offset:53248
    ds_read_b128 v[200:203], v3 offset:14336
    ds_read_b128 v[204:207], v3 offset:15360
    s_add_u32 m0, s49, 40960
    s_xor_b32 s57, s48, 106496
    buffer_load_dwordx4 v2, s[16:19], s57 offen nt lds
    s_waitcnt lgkmcnt(2)
    v_mfma_f32_16x16x32_bf16 v[56:59], v[208:211], v[192:195], v[56:59]
    v_mfma_f32_16x16x32_bf16 v[60:63], v[208:211], v[196:199], v[60:63]
    s_nop 1
    v_permlane16_swap_b32 v48, v49
    s_nop 0
    v_add_f32 v48, v48, v49
    v_mov_b32 v49, v48
    s_nop 1
    v_permlane32_swap_b32 v48, v49
    s_nop 0
    v_add_f32 v48, v48, v49
    ds_write_b32 v18, v48 offset:1024
    s_waitcnt vmcnt(7)
    s_barrier
    ds_read_b64_tr_b16 v[212:213], v4 offset:57344
    ds_read_b64_tr_b16 v[214:215], v4 offset:61440
    ds_read_b128 v[192:195], v3 offset:16384
    ds_read_b128 v[196:199], v3 offset:17408
    s_add_u32 m0, s49, 49152
    s_xor_b32 s57, s48, 114688
    buffer_load_dwordx4 v2, s[16:19], s57 offen nt lds
    s_waitcnt lgkmcnt(2)
    v_mfma_f32_16x16x32_bf16 v[56:59], v[212:215], v[200:203], v[56:59]
    v_mfma_f32_16x16x32_bf16 v[60:63], v[212:215], v[204:207], v[60:63]
    s_waitcnt vmcnt(6)
    s_barrier
    ds_read_b64_tr_b16 v[208:209], v4 offset:0
    ds_read_b64_tr_b16 v[210:211], v4 offset:4096
    ds_read_b128 v[200:203], v3 offset:18432
    ds_read_b128 v[204:207], v3 offset:19456
    s_add_u32 m0, s49, 57344
    s_xor_b32 s57, s48, 122880
    buffer_load_dwordx4 v2, s[16:19], s57 offen nt lds
    s_waitcnt lgkmcnt(2)
    v_mfma_f32_16x16x32_bf16 v[56:59], v[208:211], v[192:195], v[56:59]
    v_mfma_f32_16x16x32_bf16 v[60:63], v[208:211], v[196:199], v[60:63]
    s_cmp_lg_u32 s3, 0
    s_cbranch_scc1 L_w_45
    v_add_u32 v17, 132096, v17
    ds_read_b128 v[32:35], v17
    ds_read_b128 v[36:39], v17 offset:16
    v_and_b32 v40, 16, v0
    v_cmp_ne_u32 vcc, 0, v40
    s_nop 1
    v_cndmask_b32 v40, v24, v25, vcc
    s_waitcnt lgkmcnt(0)
    v_add_f32 v32, v32, v33
    v_add_f32 v34, v34, v35
    v_add_f32 v36, v36, v37
    v_add_f32 v38, v38, v39
    v_add_f32 v32, v32, v34
    v_add_f32 v36, v36, v38
    v_add_f32 v41, v32, v36
    v_mov_b32 v42, s100
    v_mov_b32 v43, s101
    s_mov_b64 exec, 0xffffffff
    buffer_store_dwordx4 v[40:43], v3, s[36:39], s62 offen sc1
    s_mov_b64 exec, -1
L_w_45:
    s_waitcnt vmcnt(6)
    s_barrier
    ds_read_b64_tr_b16 v[212:213], v4 offset:8192
    ds_read_b64_tr_b16 v[214:215], v4 offset:12288
    ds_read_b128 v[192:195], v3 offset:20480
    ds_read_b128 v[196:199], v3 offset:21504
    s_add_u32 m0, s49, 0
    s_xor_b32 s57, s48, 131072
    buffer_load_dwordx4 v2, s[16:19], s57 offen nt lds
    s_waitcnt lgkmcnt(2)
    v_mfma_f32_16x16x32_bf16 v[56:59], v[212:215], v[200:203], v[56:59]
    v_mfma_f32_16x16x32_bf16 v[60:63], v[212:215], v[204:207], v[60:63]
    v_lshrrev_b32 v11, 3, v0
    v_lshlrev_b32 v11, 9, v11
    v_lshl_add_u32 v11, v14, 4, v11
    s_lshl_b32 s55, s42, 2
    s_add_u32 s55, s55, s43
    s_lshl_b32 s58, s55, 16
    s_lshl_b32 s55, s55, 12
    s_lshl_b32 s4, s44, 6
    s_add_u32 s55, s55, s4
    s_add_u32 s55, s55, 0x100000
    s_lshl_b32 s4, s3, 10
    s_add_u32 s58, s58, s4
    s_lshl_b32 s4, s44, 7
    s_add_u32 s58, s58, s4
    s_add_u32 s58, s58, 0x400000
    v_and_b32 v26, 1, v7
    v_lshl_add_u32 v26, v26, 2, v13
    v_lshlrev_b32 v26, 13, v26
    v_lshl_add_u32 v26, v14, 4, v26
    v_lshrrev_b32 v28, 1, v7
    v_lshl_add_u32 v26, v28, 6, v26
    s_lshl_b32 s53, s45, 14
    s_and_b32 s4, s3, 1
    s_lshl_b32 s4, s4, 12
    s_add_u32 s53, s53, s4
    s_lshr_b32 s4, s3, 1
    s_lshl_b32 s4, s4, 8
    s_add_u32 s53, s53, s4
    s_add_u32 s53, s53, 0x140000
    s_add_u32 s54, s53, 0x2000
    s_waitcnt vmcnt(6)
    s_barrier
    ds_read_b64_tr_b16 v[208:209], v4 offset:16384
    ds_read_b64_tr_b16 v[210:211], v4 offset:20480
    ds_read_b128 v[200:203], v3 offset:22528
    ds_read_b128 v[204:207], v3 offset:23552
    s_add_u32 m0, s49, 8192
    s_xor_b32 s57, s48, 139264
    buffer_load_dwordx4 v2, s[16:19], s57 offen nt lds
    s_waitcnt lgkmcnt(2)
    v_mfma_f32_16x16x32_bf16 v[56:59], v[208:211], v[192:195], v[56:59]
    v_mfma_f32_16x16x32_bf16 v[60:63], v[208:211], v[196:199], v[60:63]
    s_waitcnt vmcnt(6)
    s_barrier
    ds_read_b64_tr_b16 v[212:213], v4 offset:24576
    ds_read_b64_tr_b16 v[214:215], v4 offset:28672
    ds_read_b128 v[192:195], v3 offset:24576
    ds_read_b128 v[196:199], v3 offset:25600
    s_add_u32 m0, s49, 16384
    s_xor_b32 s57, s48, 147456
    buffer_load_dwordx4 v2, s[16:19], s57 offen nt lds
    s_waitcnt lgkmcnt(2)
    v_mfma_f32_16x16x32_bf16 v[56:59], v[212:215], v[200:203], v[56:59]
    v_mfma_f32_16x16x32_bf16 v[60:63], v[212:215], v[204:207], v[60:63]
    s_waitcnt vmcnt(6)
    s_barrier
    ds_read_b64_tr_b16 v[208:209], v4 offset:32768
    ds_read_b64_tr_b16 v[210:211], v4 offset:36864
    ds_read_b128 v[200:203], v3 offset:26624
    ds_read_b128 v[204:207], v3 offset:27648
    s_add_u32 m0, s49, 24576
    s_xor_b32 s57, s48, 155648
    buffer_load_dwordx4 v2, s[16:19], s57 offen nt lds
    s_waitcnt lgkmcnt(2)
    v_mfma_f32_16x16x32_bf16 v[56:59], v[208:211], v[192:195], v[56:59]
    v_mfma_f32_16x16x32_bf16 v[60:63], v[208:211], v[196:199], v[60:63]
    s_waitcnt vmcnt(6)
    s_barrier
    ds_read_b64_tr_b16 v[212:213], v4 offset:40960
    ds_read_b64_tr_b16 v[214:215], v4 offset:45056
    ds_read_b128 v[192:195], v3 offset:28672
    ds_read_b128 v[196:199], v3 offset:29696
    s_add_u32 m0, s49, 32768
    s_xor_b32 s57, s48, 163840
    buffer_load_dwordx4 v2, s[16:19], s57 offen nt lds
    s_waitcnt lgkmcnt(2)
    v_mfma_f32_16x16x32_bf16 v[56:59], v[212:215], v[200:203], v[56:59]
    v_mfma_f32_16x16x32_bf16 v[60:63], v[212:215], v[204:207], v[60:63]
    s_waitcnt vmcnt(6)
    s_barrier
    ds_read_b64_tr_b16 v[208:209], v4 offset:49152
    ds_read_b64_tr_b16 v[210:211], v4 offset:53248
    ds_read_b128 v[200:203], v3 offset:30720
    ds_read_b128 v[204:207], v3 offset:31744
    s_add_u32 m0, s49, 40960
    s_xor_b32 s57, s48, 172032
    buffer_load_dwordx4 v2, s[16:19], s57 offen nt lds
    s_waitcnt lgkmcnt(2)
    v_mfma_f32_16x16x32_bf16 v[56:59], v[208:211], v[192:195], v[56:59]
    v_mfma_f32_16x16x32_bf16 v[60:63], v[208:211], v[196:199], v[60:63]
    s_waitcnt vmcnt(6)
    s_barrier
    ds_read_b64_tr_b16 v[212:213], v4 offset:57344
    ds_read_b64_tr_b16 v[214:215], v4 offset:61440
    ds_read_b128 v[192:195], v3 offset:32768
    ds_read_b128 v[196:199], v3 offset:33792
    s_add_u32 m0, s49, 49152
    s_xor_b32 s57, s48, 180224
    buffer_load_dwordx4 v2, s[16:19], s57 offen nt lds
    s_waitcnt lgkmcnt(2)
    v_mfma_f32_16x16x32_bf16 v[56:59], v[212:215], v[200:203], v[56:59]
    v_mfma_f32_16x16x32_bf16 v[60:63], v[212:215], v[204:207], v[60:63]
    s_waitcnt vmcnt(6)
    s_barrier
    ds_read_b64_tr_b16 v[208:209], v4 offset:0
    ds_read_b64_tr_b16 v[210:211], v4 offset:4096
    ds_read_b128 v[200:203], v3 offset:34816
    ds_read_b128 v[204:207], v3 offset:35840
    s_add_u32 m0, s49, 57344
    s_xor_b32 s57, s48, 188416
    buffer_load_dwordx4 v2, s[16:19], s57 offen nt lds
    s_waitcnt lgkmcnt(2)
    v_mfma_f32_16x16x32_bf16 v[56:59], v[208:211], v[192:195], v[56:59]
    v_mfma_f32_16x16x32_bf16 v[60:63], v[208:211], v[196:199], v[60:63]
    s_waitcnt vmcnt(6)
    s_barrier
    ds_read_b64_tr_b16 v[212:213], v4 offset:8192
    ds_read_b64_tr_b16 v[214:215], v4 offset:12288
    ds_read_b128 v[192:195], v3 offset:36864
    ds_read_b128 v[196:199], v3 offset:37888
    s_add_u32 m0, s49, 0
    s_xor_b32 s57, s48, 196608
    buffer_load_dwordx4 v2, s[16:19], s57 offen nt lds
    s_waitcnt lgkmcnt(2)
    v_mfma_f32_16x16x32_bf16 v[56:59], v[212:215], v[200:203], v[56:59]
    v_mfma_f32_16x16x32_bf16 v[60:63], v[212:215], v[204:207], v[60:63]
    s_waitcnt vmcnt(6)
    s_barrier
    ds_read_b64_tr_b16 v[208:209], v4 offset:16384
    ds_read_b64_tr_b16 v[210:211], v4 offset:20480
    ds_read_b128 v[200:203], v3 offset:38912
    ds_read_b128 v[204:207], v3 offset:39936
    s_add_u32 m0, s49, 8192
    s_xor_b32 s57, s48, 204800
    buffer_load_dwordx4 v2, s[16:19], s57 offen nt lds
    s_waitcnt lgkmcnt(2)
    v_mfma_f32_16x16x32_bf16 v[56:59], v[208:211], v[192:195], v[56:59]
    v_mfma_f32_16x16x32_bf16 v[60:63], v[208:211], v[196:199], v[60:63]
    s_waitcnt vmcnt(6)
    s_barrier
    ds_read_b64_tr_b16 v[212:213], v4 offset:24576
    ds_read_b64_tr_b16 v[214:215], v4 offset:28672
    ds_read_b128 v[192:195], v3 offset:40960
    ds_read_b128 v[196:199], v3 offset:41984
    s_add_u32 m0, s49, 16384
    s_xor_b32 s57, s48, 212992
    buffer_load_dwordx4 v2, s[16:19], s57 offen nt lds
    s_waitcnt lgkmcnt(2)
    v_mfma_f32_16x16x32_bf16 v[56:59], v[212:215], v[200:203], v[56:59]
    v_mfma_f32_16x16x32_bf16 v[60:63], v[212:215], v[204:207], v[60:63]
    s_waitcnt vmcnt(6)
    s_barrier
    ds_read_b64_tr_b16 v[208:209], v4 offset:32768
    ds_read_b64_tr_b16 v[210:211], v4 offset:36864
    ds_read_b128 v[200:203], v3 offset:43008
    ds_read_b128 v[204:207], v3 offset:44032
    buffer_load_dwordx4 v[96:99], v11, s[36:39], s55 offen sc1
    s_add_u32 m0, s49, 24576
    s_xor_b32 s57, s48, 221184
    buffer_load_dwordx4 v2, s[16:19], s57 offen nt lds
    s_waitcnt lgkmcnt(2)
    v_mfma_f32_16x16x32_bf16 v[56:59], v[208:211], v[192:195], v[56:59]
    v_mfma_f32_16x16x32_bf16 v[60:63], v[208:211], v[196:199], v[60:63]
    s_waitcnt vmcnt(7)
    s_barrier
    ds_read_b64_tr_b16 v[212:213], v4 offset:40960
    ds_read_b64_tr_b16 v[214:215], v4 offset:45056
    ds_read_b128 v[192:195], v3 offset:45056
    ds_read_b128 v[196:199], v3 offset:46080
    s_add_u32 m0, s49, 32768
    s_xor_b32 s57, s48, 229376
    buffer_load_dwordx4 v2, s[16:19], s57 offen nt lds
    s_waitcnt lgkmcnt(2)
    v_mfma_f32_16x16x32_bf16 v[56:59], v[212:215], v[200:203], v[56:59]
    v_mfma_f32_16x16x32_bf16 v[60:63], v[212:215], v[204:207], v[60:63]
    s_waitcnt vmcnt(7)
    s_barrier
    ds_read_b64_tr_b16 v[208:209], v4 offset:49152
    ds_read_b64_tr_b16 v[210:211], v4 offset:53248
    ds_read_b128 v[200:203], v3 offset:47104
    ds_read_b128 v[204:207], v3 offset:48128
    s_add_u32 m0, s49, 40960
    s_xor_b32 s57, s48, 237568
    buffer_load_dwordx4 v2, s[16:19], s57 offen nt lds
    s_waitcnt lgkmcnt(2)
    v_mfma_f32_16x16x32_bf16 v[56:59], v[208:211], v[192:195], v[56:59]
    v_mfma_f32_16x16x32_bf16 v[60:63], v[208:211], v[196:199], v[60:63]
    s_waitcnt vmcnt(7)
    s_barrier
    ds_read_b64_tr_b16 v[212:213], v4 offset:57344
    ds_read_b64_tr_b16 v[214:215], v4 offset:61440
    ds_read_b128 v[192:195], v3 offset:49152
    ds_read_b128 v[196:199], v3 offset:50176
    s_add_u32 m0, s49, 49152
    s_xor_b32 s57, s48, 245760
    buffer_load_dwordx4 v2, s[16:19], s57 offen nt lds
    s_waitcnt lgkmcnt(2)
    v_mfma_f32_16x16x32_bf16 v[56:59], v[212:215], v[200:203], v[56:59]
    v_mfma_f32_16x16x32_bf16 v[60:63], v[212:215], v[204:207], v[60:63]
    s_waitcnt vmcnt(7)
    s_barrier
    ds_read_b64_tr_b16 v[208:209], v4 offset:0
    ds_read_b64_tr_b16 v[210:211], v4 offset:4096
    ds_read_b128 v[200:203], v3 offset:51200
    ds_read_b128 v[204:207], v3 offset:52224
    s_add_u32 m0, s49, 57344
    s_xor_b32 s57, s48, 253952
    buffer_load_dwordx4 v2, s[16:19], s57 offen nt lds
    s_waitcnt lgkmcnt(2)
    v_mfma_f32_16x16x32_bf16 v[56:59], v[208:211], v[192:195], v[56:59]
    v_mfma_f32_16x16x32_bf16 v[60:63], v[208:211], v[196:199], v[60:63]
    s_and_b32 s4, s100, 0xfff
    v_mov_b32 v216, s4
    s_bfe_u32 s4, s100, 0xc000c
    v_mov_b32 v217, s4
    s_lshr_b64 s[4:5], s[100:101], 24
    s_and_b32 s5, s4, 0xfff
    v_mov_b32 v218, s5
    s_bfe_u32 s4, s4, 0xc000c
    v_mov_b32 v219, s4
    v_mov_b32 v220, 0xfff
    v_mov_b32 v224, 0
    v_mov_b32 v225, 0
    v_mov_b32 v226, 0
    v_mov_b32 v227, 0
    s_and_b32 s4, s3, 1
    s_lshl_b32 s4, s4, 13
    s_lshr_b32 s5, s3, 1
    s_lshl_b32 s5, s5, 10
    s_add_u32 s4, s4, s5
    v_add_u32 v18, s4, v3
    s_lshr_b32 s4, s3, 2
    s_lshl_b32 s4, s4, 13
    v_add_u32 v1, s4, v3
    s_waitcnt vmcnt(7)
    s_barrier
    ds_read_b64_tr_b16 v[212:213], v4 offset:8192
    ds_read_b64_tr_b16 v[214:215], v4 offset:12288
    ds_read_b128 v[192:195], v3 offset:53248
    ds_read_b128 v[196:199], v3 offset:54272
    buffer_load_dwordx4 v[232:235], v3, s[36:39], s59 offen sc1
    s_add_u32 m0, s49, 0
    s_add_u32 s57, s63, 0
    buffer_load_dwordx4 v30, s[24:27], s57 offen nt lds
    s_waitcnt lgkmcnt(2)
    v_mfma_f32_16x16x32_bf16 v[56:59], v[212:215], v[200:203], v[56:59]
    v_mfma_f32_16x16x32_bf16 v[60:63], v[212:215], v[204:207], v[60:63]
    v_lshrrev_b32 v16, 3, v0
    v_lshlrev_b32 v16, 13, v16
    v_and_b32 v28, 7, v0
    v_lshl_add_u32 v16, v28, 4, v16
    s_lshr_b32 s96, s41, 4
    s_lshl_b32 s96, s96, 17
    s_and_b32 s4, s41, 15
    s_lshl_b32 s4, s4, 9
    s_add_u32 s96, s96, s4
    s_lshl_b32 s4, s3, 7
    s_add_u32 s96, s96, s4
    s_add_u32 s96, s96, 0x400000
    s_add_u32 s40, s96, 0x10000
    v_lshlrev_b32 v17, 11, v28
    v_and_b32 v28, 1, v7
    v_lshl_add_u32 v17, v28, 2, v17
    v_lshrrev_b32 v28, 5, v0
    v_lshl_add_u32 v17, v28, 1, v17
    s_lshr_b32 s4, s41, 3
    s_and_b32 s4, s4, 1
    s_lshl_b32 s99, s4, 15
    s_and_b32 s4, s3, 1
    s_lshl_b32 s4, s4, 14
    s_add_u32 s99, s99, s4
    s_lshl_b32 s4, s46, 7
    s_add_u32 s99, s99, s4
    s_and_b32 s4, s41, 7
    s_lshl_b32 s4, s4, 4
    s_add_u32 s99, s99, s4
    s_lshr_b32 s4, s3, 1
    s_lshl_b32 s4, s4, 3
    s_add_u32 s99, s99, s4
    s_mov_b64 s[84:85], -1
    s_mov_b64 s[86:87], -1
    s_mov_b64 s[88:89], -1
    s_mov_b64 s[90:91], -1
    s_waitcnt vmcnt(8)
    s_barrier
    ds_read_b64_tr_b16 v[208:209], v4 offset:16384
    ds_read_b64_tr_b16 v[210:211], v4 offset:20480
    ds_read_b128 v[200:203], v3 offset:55296
    ds_read_b128 v[204:207], v3 offset:56320
    s_waitcnt lgkmcnt(2)
    v_mfma_f32_16x16x32_bf16 v[56:59], v[208:211], v[192:195], v[56:59]
    v_mfma_f32_16x16x32_bf16 v[60:63], v[208:211], v[196:199], v[60:63]
    s_waitcnt vmcnt(6)
    s_barrier
    ds_read_b64_tr_b16 v[212:213], v4 offset:24576
    ds_read_b64_tr_b16 v[214:215], v4 offset:28672
    ds_read_b128 v[192:195], v3 offset:57344
    ds_read_b128 v[196:199], v3 offset:58368
    s_waitcnt lgkmcnt(2)
    v_mfma_f32_16x16x32_bf16 v[56:59], v[212:215], v[200:203], v[56:59]
    v_mfma_f32_16x16x32_bf16 v[60:63], v[212:215], v[204:207], v[60:63]
    s_waitcnt vmcnt(5)
    s_barrier
    ds_read_b64_tr_b16 v[208:209], v4 offset:32768
    ds_read_b64_tr_b16 v[210:211], v4 offset:36864
    ds_read_b128 v[200:203], v3 offset:59392
    ds_read_b128 v[204:207], v3 offset:60416
    s_waitcnt lgkmcnt(2)
    v_mfma_f32_16x16x32_bf16 v[56:59], v[208:211], v[192:195], v[56:59]
    v_mfma_f32_16x16x32_bf16 v[60:63], v[208:211], v[196:199], v[60:63]
    s_waitcnt vmcnt(7)
L_mlp_46:
    v_cmp_ne_u64 vcc, s[100:101], v[98:99]
    s_cmp_eq_u64 vcc, 0
    s_cbranch_scc1 L_mlok_47
    s_sleep 2
    buffer_load_dwordx4 v[96:99], v11, s[36:39], s55 offen sc1
    s_sub_u32 s51, s51, 1
    s_waitcnt vmcnt(0)
    s_cbranch_scc0 L_mlp_46
    s_endpgm
L_mlok_47:
    v_max_f32_dpp v104, v96, v96 row_ror:8 row_mask:0xf bank_mask:0xf
    v_mov_b32 v105, v104
    s_nop 1
    v_permlane16_swap_b32 v104, v105
    s_nop 0
    v_max_f32 v104, v104, v105
    v_mov_b32 v105, v104
    s_nop 1
    v_permlane32_swap_b32 v104, v105
    s_nop 0
    v_max_f32 v104, v104, v105
    v_sub_f32 v106, v96, v104
    v_exp_f32 v106, v106
    s_nop 0
    v_mul_f32 v107, v106, v97
    s_nop 1
    v_add_f32_dpp v104, v107, v107 row_ror:8 row_mask:0xf bank_mask:0xf
    v_mov_b32 v105, v104
    s_nop 1
    v_permlane16_swap_b32 v104, v105
    s_nop 0
    v_add_f32 v104, v104, v105
    v_mov_b32 v105, v104
    s_nop 1
    v_permlane32_swap_b32 v104, v105
    s_nop 0
    v_add_f32 v104, v104, v105
    v_rcp_f32 v104, v104
    s_nop 0
    v_mul_f32 v106, v106, v104
    s_waitcnt vmcnt(4)
    s_barrier
    ds_read_b64_tr_b16 v[212:213], v4 offset:40960
    ds_read_b64_tr_b16 v[214:215], v4 offset:45056
    ds_read_b128 v[192:195], v3 offset:61440
    ds_read_b128 v[196:199], v3 offset:62464
    s_waitcnt lgkmcnt(2)
    v_mfma_f32_16x16x32_bf16 v[56:59], v[212:215], v[200:203], v[56:59]
    v_mfma_f32_16x16x32_bf16 v[60:63], v[212:215], v[204:207], v[60:63]
    s_waitcnt vmcnt(3)
    s_barrier
    ds_read_b64_tr_b16 v[208:209], v4 offset:49152
    ds_read_b64_tr_b16 v[210:211], v4 offset:53248
    ds_read_b128 v[200:203], v3 offset:63488
    ds_read_b128 v[204:207], v3 offset:64512
    s_waitcnt lgkmcnt(2)
    v_mfma_f32_16x16x32_bf16 v[56:59], v[208:211], v[192:195], v[56:59]
    v_mfma_f32_16x16x32_bf16 v[60:63], v[208:211], v[196:199], v[60:63]
    s_waitcnt vmcnt(2)
    s_barrier
    ds_read_b64_tr_b16 v[212:213], v4 offset:57344
    ds_read_b64_tr_b16 v[214:215], v4 offset:61440
    s_waitcnt lgkmcnt(0)
    v_mfma_f32_16x16x32_bf16 v[56:59], v[212:215], v[200:203], v[56:59]
    v_mfma_f32_16x16x32_bf16 v[60:63], v[212:215], v[204:207], v[60:63]
    s_nop 6
    v_cvt_pk_bf16_f32 v32, v56, v57
    v_cvt_pk_bf16_f32 v33, v58, v59
    v_cvt_pk_bf16_f32 v34, v60, v61
    v_cvt_pk_bf16_f32 v35, v62, v63
    v_min_u32 v32, -2, v32
    v_min_u32 v33, -2, v33
    v_min_u32 v34, -2, v34
    v_min_u32 v35, -2, v35
    s_nop 0
    v_permlane16_swap_b32 v32, v34
    v_permlane16_swap_b32 v33, v35
    s_cmp_eq_u32 s81, 0
    s_cbranch_scc1 L_dev_48
    buffer_store_dwordx4 v[32:35], v26, s[36:39], s58 offen
    s_branch L_st_49
L_dev_48:
    buffer_store_dwordx4 v[32:35], v26, s[36:39], s58 offen sc1
L_st_49:
L_ga_50:
    buffer_load_dwordx4 v[160:163], v3, s[36:39], s59 offen sc1
    s_waitcnt vmcnt(0)
    v_max3_u32 v24, v160, v161, v162
    v_max_u32 v24, v24, v163
    v_cmp_eq_u32 vcc, -1, v24
    s_and_b64 exec, exec, vcc
    s_cbranch_scc0 L_gaok_51
    s_sleep 1
    s_sub_u32 s51, s51, 1
    s_cbranch_scc0 L_ga_50
    s_endpgm
L_gaok_51:
    s_mov_b64 exec, -1
    v_lshlrev_b32 v36, 16, v160
    v_and_b32 v37, 0xffff0000, v160
    v_lshlrev_b32 v38, 16, v161
    v_and_b32 v39, 0xffff0000, v161
    v_lshlrev_b32 v40, 16, v162
    v_and_b32 v41, 0xffff0000, v162
    v_lshlrev_b32 v42, 16, v163
    v_and_b32 v43, 0xffff0000, v163
    v_mul_f32 v36, v36, v106
    v_mul_f32 v37, v37, v106
    v_mul_f32 v38, v38, v106
    v_mul_f32 v39, v39, v106
    v_mul_f32 v40, v40, v106
    v_mul_f32 v41, v41, v106
    v_mul_f32 v42, v42, v106
    v_mul_f32 v43, v43, v106
    v_permlane32_swap_b32 v36, v40
    v_permlane32_swap_b32 v37, v41
    v_permlane32_swap_b32 v38, v42
    v_permlane32_swap_b32 v39, v43
    v_add_f32 v36, v36, v40
    v_add_f32 v37, v37, v41
    v_add_f32 v38, v38, v42
    v_add_f32 v39, v39, v43
    s_nop 0
    v_permlane16_swap_b32 v36, v38
    v_permlane16_swap_b32 v37, v39
    v_add_f32 v36, v36, v38
    v_add_f32 v37, v37, v39
    s_nop 0
    v_add_f32_dpp v38, v36, v36 row_ror:8 row_mask:0xf bank_mask:0xf
    v_add_f32_dpp v39, v37, v37 row_ror:8 row_mask:0xf bank_mask:0xf
    v_cvt_pk_bf16_f32 v120, v38, v39
    v_min_u32 v120, -2, v120
    v_mov_b32 v121, v120
    s_nop 1
    v_permlane16_swap_b32 v120, v121
    s_nop 0
    v_mov_b32 v122, v120
    v_mov_b32 v123, v121
    s_nop 1
    v_permlane32_swap_b32 v120, v122
    v_permlane32_swap_b32 v121, v123
    s_mov_b64 exec, 0xff
    buffer_store_dwordx4 v[120:123], v3, s[36:39], s47 offen sc1
    s_mov_b64 exec, -1
    s_add_u32 m0, s49, 8192
    s_add_u32 s57, s63, 131072
    buffer_load_dwordx4 v30, s[24:27], s57 offen nt lds
    s_add_u32 m0, s49, 16384
    s_add_u32 s57, s63, 262144
    buffer_load_dwordx4 v30, s[24:27], s57 offen nt lds
    s_add_u32 m0, s49, 24576
    s_add_u32 s57, s63, 393216
    buffer_load_dwordx4 v30, s[24:27], s57 offen nt lds
    s_waitcnt vmcnt(0)
    s_barrier
    ds_read_b64_tr_b16 v[128:129], v29 offset:0
    ds_read_b64_tr_b16 v[130:131], v29 offset:512
    ds_read_b64_tr_b16 v[132:133], v29 offset:4096
    ds_read_b64_tr_b16 v[134:135], v29 offset:4608
    ds_read_b64_tr_b16 v[136:137], v29 offset:8192
    ds_read_b64_tr_b16 v[138:139], v29 offset:8704
    ds_read_b64_tr_b16 v[140:141], v29 offset:12288
    ds_read_b64_tr_b16 v[142:143], v29 offset:12800
    ds_read_b64_tr_b16 v[144:145], v29 offset:16384
    ds_read_b64_tr_b16 v[146:147], v29 offset:16896
    ds_read_b64_tr_b16 v[148:149], v29 offset:20480
    ds_read_b64_tr_b16 v[150:151], v29 offset:20992
    ds_read_b64_tr_b16 v[152:153], v29 offset:24576
    ds_read_b64_tr_b16 v[154:155], v29 offset:25088
    ds_read_b64_tr_b16 v[156:157], v29 offset:28672
    ds_read_b64_tr_b16 v[158:159], v29 offset:29184
    s_waitcnt lgkmcnt(0)
L_hb_52:
    s_mov_b64 exec, s[84:85]
    buffer_load_dwordx4 v[168:171], v12, s[36:39], s53 offen sc1
    s_mov_b64 exec, s[86:87]
    buffer_load_dwordx4 v[172:175], v12, s[36:39], s54 offen sc1
L_hbe_54:
    s_mov_b64 exec, s[84:85]
    s_cbranch_execz L_hbc_55
    s_waitcnt vmcnt(1)
    v_max3_u32 v24, v168, v169, v170
    v_max_u32 v24, v24, v171
    v_cmp_ne_u32 vcc, -1, v24
    s_andn2_b64 s[84:85], s[84:85], vcc
L_hbc_55:
    s_mov_b64 exec, s[86:87]
    s_cbranch_execz L_hbc_56
    s_waitcnt vmcnt(0)
    v_max3_u32 v24, v172, v173, v174
    v_max_u32 v24, v24, v175
    v_cmp_ne_u32 vcc, -1, v24
    s_andn2_b64 s[86:87], s[86:87], vcc
L_hbc_56:
    s_or_b64 s[4:5], s[84:85], s[86:87]
    s_cbranch_scc0 L_hbdone_53
    s_sleep 1
    s_sub_u32 s51, s51, 1
    s_cbranch_scc0 L_hb_52
    s_endpgm
L_hbdone_53:
    s_mov_b64 exec, -1
    ds_write_b128 v18, v[168:171]
    ds_write_b128 v18, v[172:175] offset:4096
    s_waitcnt lgkmcnt(0)
    s_barrier
    ds_read_b128 v[64:67], v1 offset:0
    ds_read_b128 v[68:71], v1 offset:1024
    ds_read_b128 v[72:75], v1 offset:2048
    ds_read_b128 v[76:79], v1 offset:3072
    ds_read_b128 v[80:83], v1 offset:4096
    ds_read_b128 v[84:87], v1 offset:5120
    ds_read_b128 v[88:91], v1 offset:6144
    ds_read_b128 v[92:95], v1 offset:7168
    s_waitcnt lgkmcnt(7)
    v_mfma_f32_16x16x32_bf16 v[56:59], v[128:131], v[64:67], 0
    s_waitcnt lgkmcnt(6)
    v_mfma_f32_16x16x32_bf16 v[60:63], v[132:135], v[68:71], 0
    s_waitcnt lgkmcnt(5)
    v_mfma_f32_16x16x32_bf16 v[56:59], v[136:139], v[72:75], v[56:59]
    s_waitcnt lgkmcnt(4)
    v_mfma_f32_16x16x32_bf16 v[60:63], v[140:143], v[76:79], v[60:63]
    s_waitcnt lgkmcnt(3)
    v_mfma_f32_16x16x32_bf16 v[56:59], v[144:147], v[80:83], v[56:59]
    s_waitcnt lgkmcnt(2)
    v_mfma_f32_16x16x32_bf16 v[60:63], v[148:151], v[84:87], v[60:63]
    s_waitcnt lgkmcnt(1)
    v_mfma_f32_16x16x32_bf16 v[56:59], v[152:155], v[88:91], v[56:59]
    s_waitcnt lgkmcnt(0)
    v_mfma_f32_16x16x32_bf16 v[60:63], v[156:159], v[92:95], v[60:63]
    s_nop 7
    v_add_f32 v56, v56, v60
    v_add_f32 v57, v57, v61
    v_add_f32 v58, v58, v62
    v_add_f32 v59, v59, v63
    v_bfi_b32 v56, v220, v216, v56
    v_bfi_b32 v57, v220, v217, v57
    v_bfi_b32 v58, v220, v218, v58
    v_bfi_b32 v59, v220, v219, v59
    s_cmp_eq_u32 s81, 0
    s_cbranch_scc1 L_dev_57
    buffer_store_dwordx4 v[56:59], v3, s[36:39], s59 offen
    s_branch L_st_58
L_dev_57:
    buffer_store_dwordx4 v[56:59], v3, s[36:39], s59 offen sc1
L_st_58:
    s_cmp_ge_u32 s3, 4
    s_cbranch_scc1 L_exit
    s_waitcnt vmcnt(0)
L_hc_59:
    s_mov_b64 exec, s[88:89]
    buffer_load_dwordx4 v[160:163], v16, s[36:39], s96 offen sc1
    s_mov_b64 exec, s[90:91]
    buffer_load_dwordx4 v[164:167], v16, s[36:39], s40 offen sc1
L_hce_61:
    s_mov_b64 exec, s[88:89]
    s_cbranch_execz L_hcc_62
    s_waitcnt vmcnt(1)
    v_xor_b32 v160, v216, v160
    v_xor_b32 v161, v217, v161
    v_xor_b32 v162, v218, v162
    v_xor_b32 v163, v219, v163
    v_or3_b32 v24, v160, v161, v162
    v_or_b32 v24, v24, v163
    v_and_b32 v24, v220, v24
    v_cmp_eq_u32 vcc, 0, v24
    s_andn2_b64 s[88:89], s[88:89], vcc
    s_mov_b64 exec, vcc
    v_add_f32 v224, v224, v160
    v_add_f32 v225, v225, v161
    v_add_f32 v226, v226, v162
    v_add_f32 v227, v227, v163
L_hcc_62:
    s_mov_b64 exec, s[90:91]
    s_cbranch_execz L_hcc_63
    s_waitcnt vmcnt(0)
    v_xor_b32 v164, v216, v164
    v_xor_b32 v165, v217, v165
    v_xor_b32 v166, v218, v166
    v_xor_b32 v167, v219, v167
    v_or3_b32 v24, v164, v165, v166
    v_or_b32 v24, v24, v167
    v_and_b32 v24, v220, v24
    v_cmp_eq_u32 vcc, 0, v24
    s_andn2_b64 s[90:91], s[90:91], vcc
    s_mov_b64 exec, vcc
    v_add_f32 v224, v224, v164
    v_add_f32 v225, v225, v165
    v_add_f32 v226, v226, v166
    v_add_f32 v227, v227, v167
L_hcc_63:
    s_or_b64 s[4:5], s[88:89], s[90:91]
    s_cbranch_scc0 L_hcdone_60
    s_sub_u32 s51, s51, 1
    s_cbranch_scc0 L_hc_59
    s_endpgm
L_hcdone_60:
    s_mov_b64 exec, -1
    s_nop 1
    v_permlane32_swap_b32 v224, v225
    v_permlane32_swap_b32 v226, v227
    s_nop 0
    v_add_f32 v224, v224, v225
    v_add_f32 v226, v226, v227
    s_nop 1
    v_permlane16_swap_b32 v224, v226
    s_nop 0
    v_add_f32 v224, v224, v226
    s_nop 1
    v_add_f32_dpp v225, v224, v224 row_ror:8 row_mask:0xf bank_mask:0xf
    v_cvt_pk_bf16_f32 v225, v225, v225
    s_mov_b32 exec_lo, 0x00ff00ff
    s_mov_b32 exec_hi, 0x00ff00ff
    buffer_store_short v225, v17, s[28:31], s99 offen
L_exit:
    s_endpgm
.section .rodata,"a"
.p2align 6
.amdhsa_kernel standalone__gqa_block_cached__sampling_kernel
  .amdhsa_next_free_vgpr 256
  .amdhsa_next_free_sgpr 102
  .amdhsa_accum_offset 256
  .amdhsa_group_segment_fixed_size 0
  .amdhsa_kernarg_size 64
  .amdhsa_user_sgpr_count 2
  .amdhsa_user_sgpr_kernarg_segment_ptr 1
  .amdhsa_system_sgpr_workgroup_id_x 1
  .amdhsa_float_denorm_mode_32 3
.end_amdhsa_kernel
```
